```python
import torch

def _softmax(x, axis=-1):
    return torch.softmax(x, dim=axis)
def _gelu(x):
    return torch.nn.functional.gelu(x, approximate="tanh")
def _silu(x):
    return torch.nn.functional.silu(x)
def _sigmoid(x):
    return torch.sigmoid(x)
def _layernorm(x, axis=-1, eps=1e-5):
    m = x.mean(dim=axis, keepdim=True)
    v = x.var(dim=axis, keepdim=True, unbiased=False)
    return (x - m) / torch.sqrt(v + eps)
def _scatter_add(tgt, idx, src, axis=0):
    return tgt.clone().index_add_(axis, idx, src)
def _segment_sum(src, seg, n):
    out = torch.zeros((n,) + src.shape[1:], dtype=src.dtype)
    return out.index_add_(0, seg, src)
def _pad(x, pw):
    flat = tuple(v for pair in reversed(pw) for v in pair)
    return torch.nn.functional.pad(x, flat)

kernel_name = 'standalone__low_rank_proj_linformer__decode'

def setup_inputs():

    _w = (lambda a: (lambda t: t.to(torch.bfloat16) if t.is_floating_point() else t)(torch.as_tensor(a)))
    B, H, Sq, Skv, Dh, R = 4, 32, 1, 8192, 128, 64
    return {
        "q": _w((lambda *s: torch.randn(*s, dtype=torch.bfloat16) * 0.8)(B, H, Sq, Dh)),
        "k": _w((lambda *s: torch.randn(*s, dtype=torch.bfloat16) * 0.8)(B, H, Skv, Dh)),
        "v": _w((lambda *s: torch.randn(*s, dtype=torch.bfloat16) * 0.05)(B, H, Skv, Dh)),
        "e_proj": _w((lambda *s: torch.randn(*s, dtype=torch.bfloat16) * 0.8)(R, Skv) * (Skv ** -0.5)),
        "f_proj": _w((lambda *s: torch.randn(*s, dtype=torch.bfloat16) * 0.05)(R, Skv) * (Skv ** -0.5)),
    }

def reference(q, k, v, e_proj, f_proj):
    B, H, Sq, Dh = q.shape
    kp = torch.einsum("rn,bhnd->bhrd", e_proj, k)
    vp = torch.einsum("rn,bhnd->bhrd", f_proj, v)
    scores = torch.einsum("bhqd,bhrd->bhqr", q, kp) * (Dh ** -0.5)
    p = _softmax(scores, axis=-1)
    o = torch.einsum("bhqr,bhrd->bhqd", p, vp)
    return o
```

```asm
; @launch grid=(256,1,1) block=(512,1,1) lds=158720
.amdgcn_target "amdgcn-amd-amdhsa--gfx950"
.text
.globl standalone__low_rank_proj_linformer__decode_kernel
.p2align 8
.type standalone__low_rank_proj_linformer__decode_kernel,@function
standalone__low_rank_proj_linformer__decode_kernel:
  s_load_dwordx16 s[4:19], s[0:1], 0
  s_cmp_ge_u32 s2, 256
  s_cbranch_scc1 L_done
  v_lshrrev_b32 v1, 6, v0
  v_and_b32 v0, 63, v0
  v_readfirstlane_b32 s3, v1
  v_and_b32 v126, 15, v0
  v_lshrrev_b32 v127, 4, v0
  s_lshr_b32 s52, s2, 3
  s_and_b32 s53, s2, 7
  s_lshr_b32 s89, s52, 1
  s_lshl_b32 s89, s89, 3
  s_and_b32 s56, s52, 1
  s_add_u32 s89, s89, s56
  s_lshl_b32 s54, s89, 21
  s_and_b32 s57, s53, 3
  s_lshl_b32 s56, s57, 19
  s_add_u32 s54, s54, s56
  s_cmp_ge_u32 s3, 4
  s_cbranch_scc0 L_stream
  s_sub_u32 s3, s3, 4
  v_lshrrev_b32 v69, 5, v0
  v_xor_b32 v68, v126, v69
  v_and_b32 v70, 1, v68
  v_lshlrev_b32 v70, 4, v70
  v_bfe_u32 v71, v68, 1, 1
  v_lshl_add_u32 v70, v71, 6, v70
  v_lshrrev_b32 v68, 2, v68
  v_lshl_add_u32 v70, v68, 7, v70
  v_and_b32 v68, 1, v127
  v_lshl_add_u32 v70, v68, 5, v70
  v_lshl_add_u32 v4, v69, 14, v70
  v_xor_b32 v5, 64, v4
  v_xor_b32 v6, 128, v4
  v_xor_b32 v7, 192, v4
  v_xor_b32 v8, 256, v4
  v_xor_b32 v9, 320, v4
  v_xor_b32 v10, 384, v4
  v_xor_b32 v11, 448, v4
  s_lshl_b32 s99, s57, 12
  s_lshl_b32 s56, s3, 18
  s_add_u32 s61, s99, s56
  s_lshl_b32 s62, s3, 13
  s_lshr_b32 s55, s53, 2
  s_lshl_b32 s55, s55, 9
  s_add_u32 s55, s55, s61
  s_mov_b32 s30, 1048576
  s_mov_b32 s31, 0x00020000
  s_mov_b32 s22, 268435456
  s_mov_b32 s23, 0x00020000
  s_waitcnt lgkmcnt(0)
  s_mov_b32 s28, s10
  s_mov_b32 s29, s11
  s_cmp_lt_u32 s53, 3
  s_cbranch_scc0 L_noprobe
  s_cmp_eq_u32 s3, 0
  s_cbranch_scc0 L_probed
  s_cmp_eq_u32 s53, 0
  s_cselect_b32 s20, s6, s8
  s_cselect_b32 s21, s7, s9
  s_add_u32 s56, s54, 0x70000
  s_cmp_eq_u32 s53, 2
  s_cselect_b32 s20, s18, s20
  s_cselect_b32 s21, s19, s21
  s_cselect_b32 s56, 0x180000, s56
  s_bfe_u32 s98, s52, 0x10001
  s_lshl_b32 s57, s98, 13
  s_add_u32 s56, s56, s57
  s_lshl_b32 s57, s52, 7
  s_add_u32 s56, s56, s57
  s_xor_b32 s57, s56, 0x2000
  s_mov_b32 s92, 0
  s_mov_b64 exec, 1
  .p2align 6
  s_barrier
  buffer_load_dword v80, off, s[20:23], s56 nt
  buffer_load_dword v81, off, s[20:23], s57 nt
  s_barrier
  s_waitcnt vmcnt(1)
L_gap:
  s_getreg_b32 s100, hwreg(HW_REG_IB_STS, 0, 4)
  s_add_u32 s92, s92, 1
  s_cmp_lg_u32 s100, 0
  s_cbranch_scc1 L_gap
  s_mov_b64 exec, -1
  s_branch L_noprobe
L_probed:
  s_barrier
  s_barrier
L_noprobe:
  s_mov_b32 s48, s18
  s_mov_b32 s49, s19
  s_mov_b32 s50, 1073741824
  s_mov_b32 s51, 0x00020000
  s_lshl_b32 s57, s52, 14
  s_add_u32 s57, s57, 262144
  buffer_load_dwordx4 v[84:87], off, s[48:51], s57 sc1 nt
  s_branch L_helper
L_stream:
  v_lshlrev_b32 v6, 4, v126
  v_and_b32 v7, 1, v127
  v_lshl_add_u32 v1, v7, 15, v6
  v_lshrrev_b32 v2, 1, v127
  v_lshl_add_u32 v1, v2, 14, v1
  s_lshl_b32 s56, s3, 11
  s_add_u32 s69, s54, s56
  s_lshr_b32 s56, s53, 2
  s_lshl_b32 s56, s56, 16
  s_add_u32 s54, s69, s56
  s_lshr_b32 s56, s3, 1
  s_lshl_b32 s56, s56, 12
  s_add_u32 s54, s54, s56
  s_lshl_b32 s57, s89, 8
  s_mov_b32 s22, 268435456
  s_mov_b32 s23, 0x00020000
  s_mov_b32 s38, 32768
  s_mov_b32 s39, 0x00020000
  s_mov_b32 s55, s54
  s_waitcnt lgkmcnt(0)
  s_mov_b32 s20, s6
  s_mov_b32 s21, s7
  s_mov_b32 s36, s4
  s_mov_b32 s37, s5
  s_cmp_lt_u32 s53, 3
  s_cbranch_scc0 L_go
  s_barrier
  s_barrier
L_go:
  buffer_load_dwordx4 v[8:11], v1, s[20:23], s55 offen offset:0 nt
  buffer_load_dwordx4 v[12:15], v1, s[20:23], s55 offen offset:256 nt
  buffer_load_dwordx4 v[16:19], v1, s[20:23], s55 offen offset:512 nt
  buffer_load_dwordx4 v[20:23], v1, s[20:23], s55 offen offset:768 nt
  buffer_load_dwordx4 v[24:27], v1, s[20:23], s55 offen offset:1024 nt
  s_setprio 1
  v_lshlrev_b32 v7, 3, v7
  v_lshl_add_u32 v7, v2, 2, v7
  v_add_u32 v7, s3, v7
  v_xor_b32 v7, v7, v126
  v_lshlrev_b32 v7, 4, v7
  v_lshl_add_u32 v2, v126, 9, v7
  s_lshl_b32 s56, s3, 4
  s_add_u32 s56, s56, 65536
  v_lshlrev_b32 v7, 6, v126
  v_lshl_add_u32 v7, v127, 2, v7
  v_add_u32 v3, s56, v7
  s_lshl_b32 s56, s3, 9
  s_add_u32 s56, s56, 73728
  v_lshlrev_b32 v7, 5, v126
  v_add_u32 v4, s56, v7
  s_lshl_b32 s56, s3, 7
  s_add_u32 s56, s56, 81920
  v_and_b32 v7, 1, v126
  v_lshlrev_b32 v7, 6, v7
  v_lshl_add_u32 v7, v127, 4, v7
  v_add_u32 v5, s56, v7
  buffer_load_dwordx4 v[108:111], v6, s[36:39], s57 offen offset:0 nt
  buffer_load_dwordx4 v[112:115], v6, s[36:39], s57 offen offset:512 nt
  s_mov_b32 s24, s8
  s_mov_b32 s25, s9
  s_mov_b32 s26, 268435456
  s_mov_b32 s27, 0x00020000
  s_mov_b32 s58, 0x05040100
  s_mov_b32 s59, 0x07060302
  v_mov_b32 v7, 92160
  s_waitcnt vmcnt(6)
  buffer_load_dwordx4 v[28:31], v1, s[20:23], s55 offen offset:1280 nt
  s_add_u32 s68, s54, 4096
  s_waitcnt vmcnt(6)
  buffer_load_dwordx4 v[32:35], v1, s[20:23], s55 offen offset:1536 nt
  s_waitcnt vmcnt(6)
  buffer_load_dwordx4 v[36:39], v1, s[20:23], s55 offen offset:1792 nt
  s_waitcnt vmcnt(6)
  buffer_load_dwordx4 v[40:43], v1, s[20:23], s68 offen offset:0 nt
  s_waitcnt vmcnt(6)
  buffer_load_dwordx4 v[44:47], v1, s[20:23], s68 offen offset:256 nt
  s_waitcnt vmcnt(4)
  buffer_load_dwordx4 v[48:51], v1, s[20:23], s68 offen offset:512 nt
  v_dot2_f32_bf16 v56, v8, v108, 0
  v_dot2_f32_bf16 v56, v9, v109, v56
  v_dot2_f32_bf16 v56, v10, v110, v56
  v_dot2_f32_bf16 v56, v11, v111, v56
  v_dot2_f32_bf16 v57, v12, v108, 0
  v_dot2_f32_bf16 v57, v13, v109, v57
  v_dot2_f32_bf16 v57, v14, v110, v57
  v_dot2_f32_bf16 v57, v15, v111, v57
  v_dot2_f32_bf16 v58, v16, v108, 0
  v_dot2_f32_bf16 v58, v17, v109, v58
  v_dot2_f32_bf16 v58, v18, v110, v58
  v_dot2_f32_bf16 v58, v19, v111, v58
  v_dot2_f32_bf16 v59, v20, v108, 0
  v_dot2_f32_bf16 v59, v21, v109, v59
  v_dot2_f32_bf16 v59, v22, v110, v59
  v_dot2_f32_bf16 v59, v23, v111, v59
  v_dot2_f32_bf16 v60, v24, v108, 0
  v_dot2_f32_bf16 v60, v25, v109, v60
  v_dot2_f32_bf16 v60, v26, v110, v60
  v_dot2_f32_bf16 v60, v27, v111, v60
  v_dot2_f32_bf16 v61, v28, v108, 0
  v_dot2_f32_bf16 v61, v29, v109, v61
  v_dot2_f32_bf16 v61, v30, v110, v61
  v_dot2_f32_bf16 v61, v31, v111, v61
  s_waitcnt vmcnt(4)
  buffer_load_dwordx4 v[52:55], v1, s[20:23], s68 offen offset:768 nt
  v_dot2_f32_bf16 v62, v32, v108, 0
  v_dot2_f32_bf16 v62, v33, v109, v62
  v_dot2_f32_bf16 v62, v34, v110, v62
  v_dot2_f32_bf16 v62, v35, v111, v62
  s_add_u32 s55, s54, 4194304
  s_waitcnt vmcnt(4)
  buffer_load_dwordx4 v[8:11], v1, s[20:23], s68 offen offset:1024 nt
  v_dot2_f32_bf16 v63, v36, v108, 0
  v_dot2_f32_bf16 v63, v37, v109, v63
  v_dot2_f32_bf16 v63, v38, v110, v63
  v_dot2_f32_bf16 v63, v39, v111, v63
  s_waitcnt vmcnt(4)
  buffer_load_dwordx4 v[12:15], v1, s[20:23], s68 offen offset:1280 nt
  v_cvt_pk_bf16_f32 v88, v56, v57
  v_cvt_pk_bf16_f32 v89, v58, v59
  v_cvt_pk_bf16_f32 v90, v60, v61
  v_cvt_pk_bf16_f32 v91, v62, v63
  v_dot2_f32_bf16 v56, v40, v108, 0
  v_dot2_f32_bf16 v56, v41, v109, v56
  v_dot2_f32_bf16 v56, v42, v110, v56
  v_dot2_f32_bf16 v56, v43, v111, v56
  s_waitcnt vmcnt(4)
  buffer_load_dwordx4 v[16:19], v1, s[20:23], s68 offen offset:1536 nt
  v_dot2_f32_bf16 v57, v44, v108, 0
  v_dot2_f32_bf16 v57, v45, v109, v57
  v_dot2_f32_bf16 v57, v46, v110, v57
  v_dot2_f32_bf16 v57, v47, v111, v57
  s_waitcnt vmcnt(4)
  buffer_load_dwordx4 v[20:23], v1, s[20:23], s68 offen offset:1792 nt
  v_dot2_f32_bf16 v58, v48, v108, 0
  v_dot2_f32_bf16 v58, v49, v109, v58
  v_dot2_f32_bf16 v58, v50, v110, v58
  v_dot2_f32_bf16 v58, v51, v111, v58
  s_waitcnt vmcnt(4)
  buffer_load_dwordx4 v[24:27], v1, s[20:23], s55 offen offset:0 nt
  v_dot2_f32_bf16 v59, v52, v108, 0
  v_dot2_f32_bf16 v59, v53, v109, v59
  v_dot2_f32_bf16 v59, v54, v110, v59
  v_dot2_f32_bf16 v59, v55, v111, v59
  s_waitcnt vmcnt(4)
  buffer_load_dwordx4 v[28:31], v1, s[20:23], s55 offen offset:256 nt
  s_waitcnt lgkmcnt(0)
  s_barrier
  v_dot2_f32_bf16 v60, v8, v108, 0
  v_dot2_f32_bf16 v60, v9, v109, v60
  v_dot2_f32_bf16 v60, v10, v110, v60
  v_dot2_f32_bf16 v60, v11, v111, v60
  ds_read_b128 a[0:3], v2 offset:0
  ds_read_b128 a[4:7], v2 offset:8192
  s_waitcnt vmcnt(4)
  buffer_load_dwordx4 v[32:35], v1, s[20:23], s55 offen offset:512 nt
  v_dot2_f32_bf16 v61, v12, v108, 0
  v_dot2_f32_bf16 v61, v13, v109, v61
  v_dot2_f32_bf16 v61, v14, v110, v61
  v_dot2_f32_bf16 v61, v15, v111, v61
  ds_read_b128 a[8:11], v2 offset:16384
  ds_read_b128 a[12:15], v2 offset:24576
  s_waitcnt vmcnt(4)
  buffer_load_dwordx4 v[36:39], v1, s[20:23], s55 offen offset:768 nt
  v_dot2_f32_bf16 v62, v16, v108, 0
  v_dot2_f32_bf16 v62, v17, v109, v62
  v_dot2_f32_bf16 v62, v18, v110, v62
  v_dot2_f32_bf16 v62, v19, v111, v62
  ds_read_b128 a[16:19], v2 offset:256
  ds_read_b128 a[20:23], v2 offset:8448
  s_add_u32 s68, s54, 4198400
  s_waitcnt vmcnt(4)
  buffer_load_dwordx4 v[40:43], v1, s[20:23], s55 offen offset:1024 nt
  v_dot2_f32_bf16 v63, v20, v108, 0
  v_dot2_f32_bf16 v63, v21, v109, v63
  v_dot2_f32_bf16 v63, v22, v110, v63
  v_dot2_f32_bf16 v63, v23, v111, v63
  ds_read_b128 a[24:27], v2 offset:16640
  ds_read_b128 a[28:31], v2 offset:24832
  s_waitcnt vmcnt(4)
  buffer_load_dwordx4 v[44:47], v1, s[20:23], s55 offen offset:1280 nt
  s_waitcnt lgkmcnt(0)
  v_cvt_pk_bf16_f32 v64, v56, v57
  v_cvt_pk_bf16_f32 v65, v58, v59
  v_cvt_pk_bf16_f32 v66, v60, v61
  v_cvt_pk_bf16_f32 v67, v62, v63
  v_dot2_f32_bf16 v56, v24, v112, 0
  v_dot2_f32_bf16 v56, v25, v113, v56
  v_dot2_f32_bf16 v56, v26, v114, v56
  v_dot2_f32_bf16 v56, v27, v115, v56
  v_mfma_f32_16x16x32_bf16 v[92:95], v[88:91], a[0:3], 0
  v_mfma_f32_16x16x32_bf16 v[96:99], v[88:91], a[4:7], 0
  v_mfma_f32_16x16x32_bf16 v[100:103], v[88:91], a[8:11], 0
  v_mfma_f32_16x16x32_bf16 v[104:107], v[88:91], a[12:15], 0
  v_mfma_f32_16x16x32_bf16 v[92:95], v[64:67], a[16:19], v[92:95]
  v_mfma_f32_16x16x32_bf16 v[96:99], v[64:67], a[20:23], v[96:99]
  v_mfma_f32_16x16x32_bf16 v[100:103], v[64:67], a[24:27], v[100:103]
  v_mfma_f32_16x16x32_bf16 v[104:107], v[64:67], a[28:31], v[104:107]
  s_waitcnt vmcnt(4)
  buffer_load_dwordx4 v[48:51], v1, s[20:23], s55 offen offset:1536 nt
  v_dot2_f32_bf16 v57, v28, v112, 0
  v_dot2_f32_bf16 v57, v29, v113, v57
  v_dot2_f32_bf16 v57, v30, v114, v57
  v_dot2_f32_bf16 v57, v31, v115, v57
  v_add_f32 v92, v92, v93
  v_add_f32 v96, v96, v97
  v_add_f32 v100, v100, v101
  v_add_f32 v104, v104, v105
  v_add_f32 v94, v94, v95
  v_add_f32 v98, v98, v99
  v_add_f32 v102, v102, v103
  v_add_f32 v106, v106, v107
  v_add_f32 v92, v92, v94
  v_add_f32 v96, v96, v98
  v_add_f32 v100, v100, v102
  v_add_f32 v104, v104, v106
  ds_write_b32 v3, v92 offset:8192
  ds_write_b32 v3, v96 offset:9216
  ds_write_b32 v3, v100 offset:10240
  ds_write_b32 v3, v104 offset:11264
  s_waitcnt vmcnt(4)
  buffer_load_dwordx4 v[52:55], v1, s[20:23], s55 offen offset:1792 nt
  v_dot2_f32_bf16 v58, v32, v112, 0
  v_dot2_f32_bf16 v58, v33, v113, v58
  v_dot2_f32_bf16 v58, v34, v114, v58
  v_dot2_f32_bf16 v58, v35, v115, v58
  s_waitcnt vmcnt(4)
  buffer_load_dwordx4 v[8:11], v1, s[20:23], s68 offen offset:0 nt
  v_dot2_f32_bf16 v59, v36, v112, 0
  v_dot2_f32_bf16 v59, v37, v113, v59
  v_dot2_f32_bf16 v59, v38, v114, v59
  v_dot2_f32_bf16 v59, v39, v115, v59
  s_waitcnt vmcnt(4)
  buffer_load_dwordx4 v[12:15], v1, s[20:23], s68 offen offset:256 nt
  s_waitcnt lgkmcnt(0)
  s_barrier
  ds_read_b64 v[120:121], v7
  v_dot2_f32_bf16 v60, v40, v112, 0
  v_dot2_f32_bf16 v60, v41, v113, v60
  v_dot2_f32_bf16 v60, v42, v114, v60
  v_dot2_f32_bf16 v60, v43, v115, v60
  s_waitcnt vmcnt(4)
  buffer_load_dwordx4 v[16:19], v1, s[20:23], s68 offen offset:512 nt
  s_waitcnt lgkmcnt(0)
  v_readfirstlane_b32 s56, v121
  s_nop 0
  s_add_u32 s88, s69, s56
  v_readfirstlane_b32 s56, v120
  s_nop 0
  s_add_u32 s69, s69, s56
  v_dot2_f32_bf16 v61, v44, v112, 0
  v_dot2_f32_bf16 v61, v45, v113, v61
  v_dot2_f32_bf16 v61, v46, v114, v61
  v_dot2_f32_bf16 v61, v47, v115, v61
  s_waitcnt vmcnt(4)
  buffer_load_dwordx4 v[20:23], v1, s[20:23], s68 offen offset:768 nt
  v_dot2_f32_bf16 v62, v48, v112, 0
  v_dot2_f32_bf16 v62, v49, v113, v62
  v_dot2_f32_bf16 v62, v50, v114, v62
  v_dot2_f32_bf16 v62, v51, v115, v62
  s_add_u32 s55, s69, 131072
  s_waitcnt vmcnt(4)
  buffer_load_dwordx4 v[24:27], v1, s[20:23], s68 offen offset:1024 nt
  v_dot2_f32_bf16 v63, v52, v112, 0
  v_dot2_f32_bf16 v63, v53, v113, v63
  v_dot2_f32_bf16 v63, v54, v114, v63
  v_dot2_f32_bf16 v63, v55, v115, v63
  s_waitcnt vmcnt(4)
  buffer_load_dwordx4 v[28:31], v1, s[20:23], s68 offen offset:1280 nt
  v_cvt_pk_bf16_f32 v88, v56, v57
  v_cvt_pk_bf16_f32 v89, v58, v59
  v_cvt_pk_bf16_f32 v90, v60, v61
  v_cvt_pk_bf16_f32 v91, v62, v63
  v_dot2_f32_bf16 v56, v8, v112, 0
  v_dot2_f32_bf16 v56, v9, v113, v56
  v_dot2_f32_bf16 v56, v10, v114, v56
  v_dot2_f32_bf16 v56, v11, v115, v56
  v_mfma_f32_16x16x32_bf16 v[68:71], v[88:91], a[0:3], 0
  v_mfma_f32_16x16x32_bf16 v[72:75], v[88:91], a[4:7], 0
  v_mfma_f32_16x16x32_bf16 v[76:79], v[88:91], a[8:11], 0
  v_mfma_f32_16x16x32_bf16 v[80:83], v[88:91], a[12:15], 0
  s_waitcnt vmcnt(4)
  buffer_load_dwordx4 v[32:35], v1, s[20:23], s68 offen offset:1536 nt
  v_dot2_f32_bf16 v57, v12, v112, 0
  v_dot2_f32_bf16 v57, v13, v113, v57
  v_dot2_f32_bf16 v57, v14, v114, v57
  v_dot2_f32_bf16 v57, v15, v115, v57
  s_waitcnt vmcnt(4)
  buffer_load_dwordx4 v[36:39], v1, s[20:23], s68 offen offset:1792 nt
  v_dot2_f32_bf16 v58, v16, v112, 0
  v_dot2_f32_bf16 v58, v17, v113, v58
  v_dot2_f32_bf16 v58, v18, v114, v58
  v_dot2_f32_bf16 v58, v19, v115, v58
  s_waitcnt vmcnt(4)
  v_dot2_f32_bf16 v59, v20, v112, 0
  v_dot2_f32_bf16 v59, v21, v113, v59
  v_dot2_f32_bf16 v59, v22, v114, v59
  v_dot2_f32_bf16 v59, v23, v115, v59
  s_waitcnt vmcnt(3)
  buffer_load_dwordx4 v[40:43], v1, s[20:23], s55 offen offset:0 nt
  buffer_load_dwordx4 v[44:47], v1, s[20:23], s55 offen offset:256 nt
  v_dot2_f32_bf16 v60, v24, v112, 0
  v_dot2_f32_bf16 v60, v25, v113, v60
  v_dot2_f32_bf16 v60, v26, v114, v60
  v_dot2_f32_bf16 v60, v27, v115, v60
  s_waitcnt vmcnt(4)
  buffer_load_dwordx4 v[48:51], v1, s[20:23], s55 offen offset:512 nt
  v_dot2_f32_bf16 v61, v28, v112, 0
  v_dot2_f32_bf16 v61, v29, v113, v61
  v_dot2_f32_bf16 v61, v30, v114, v61
  v_dot2_f32_bf16 v61, v31, v115, v61
  s_waitcnt vmcnt(4)
  buffer_load_dwordx4 v[52:55], v1, s[20:23], s55 offen offset:768 nt
  v_dot2_f32_bf16 v62, v32, v112, 0
  v_dot2_f32_bf16 v62, v33, v113, v62
  v_dot2_f32_bf16 v62, v34, v114, v62
  v_dot2_f32_bf16 v62, v35, v115, v62
  s_add_u32 s68, s69, 196608
  s_waitcnt vmcnt(4)
  v_dot2_f32_bf16 v63, v36, v112, 0
  v_dot2_f32_bf16 v63, v37, v113, v63
  v_dot2_f32_bf16 v63, v38, v114, v63
  v_dot2_f32_bf16 v63, v39, v115, v63
  s_waitcnt vmcnt(3)
  buffer_load_dwordx4 v[8:11], v1, s[20:23], s55 offen offset:1024 nt
  buffer_load_dwordx4 v[12:15], v1, s[20:23], s55 offen offset:1280 nt
  v_cvt_pk_bf16_f32 v64, v56, v57
  v_cvt_pk_bf16_f32 v65, v58, v59
  v_cvt_pk_bf16_f32 v66, v60, v61
  v_cvt_pk_bf16_f32 v67, v62, v63
  v_dot2_f32_bf16 v56, v40, v108, 0
  v_dot2_f32_bf16 v56, v41, v109, v56
  v_dot2_f32_bf16 v56, v42, v110, v56
  v_dot2_f32_bf16 v56, v43, v111, v56
  v_mfma_f32_16x16x32_bf16 v[68:71], v[64:67], a[16:19], v[68:71]
  v_mfma_f32_16x16x32_bf16 v[72:75], v[64:67], a[20:23], v[72:75]
  v_mfma_f32_16x16x32_bf16 v[76:79], v[64:67], a[24:27], v[76:79]
  v_mfma_f32_16x16x32_bf16 v[80:83], v[64:67], a[28:31], v[80:83]
  s_waitcnt vmcnt(4)
  buffer_load_dwordx4 v[16:19], v1, s[20:23], s55 offen offset:1536 nt
  v_dot2_f32_bf16 v57, v44, v108, 0
  v_dot2_f32_bf16 v57, v45, v109, v57
  v_dot2_f32_bf16 v57, v46, v110, v57
  v_dot2_f32_bf16 v57, v47, v111, v57
  v_add_f32 v68, v68, v69
  v_add_f32 v72, v72, v73
  v_add_f32 v76, v76, v77
  v_add_f32 v80, v80, v81
  v_add_f32 v70, v70, v71
  v_add_f32 v74, v74, v75
  v_add_f32 v78, v78, v79
  v_add_f32 v82, v82, v83
  v_add_f32 v68, v68, v70
  v_add_f32 v72, v72, v74
  v_add_f32 v76, v76, v78
  v_add_f32 v80, v80, v82
  ds_write_b32 v3, v68 offset:12288
  ds_write_b32 v3, v72 offset:13312
  ds_write_b32 v3, v76 offset:14336
  ds_write_b32 v3, v80 offset:15360
  s_waitcnt vmcnt(4)
  buffer_load_dwordx4 v[20:23], v1, s[20:23], s55 offen offset:1792 nt
  v_dot2_f32_bf16 v58, v48, v108, 0
  v_dot2_f32_bf16 v58, v49, v109, v58
  v_dot2_f32_bf16 v58, v50, v110, v58
  v_dot2_f32_bf16 v58, v51, v111, v58
  s_waitcnt vmcnt(4)
  v_dot2_f32_bf16 v59, v52, v108, 0
  v_dot2_f32_bf16 v59, v53, v109, v59
  v_dot2_f32_bf16 v59, v54, v110, v59
  v_dot2_f32_bf16 v59, v55, v111, v59
  s_waitcnt vmcnt(3)
  buffer_load_dwordx4 v[24:27], v1, s[20:23], s68 offen offset:0 nt
  buffer_load_dwordx4 v[28:31], v1, s[20:23], s68 offen offset:256 nt
  v_dot2_f32_bf16 v60, v8, v108, 0
  v_dot2_f32_bf16 v60, v9, v109, v60
  v_dot2_f32_bf16 v60, v10, v110, v60
  v_dot2_f32_bf16 v60, v11, v111, v60
  s_waitcnt vmcnt(4)
  buffer_load_dwordx4 v[32:35], v1, s[20:23], s68 offen offset:512 nt
  v_dot2_f32_bf16 v61, v12, v108, 0
  v_dot2_f32_bf16 v61, v13, v109, v61
  v_dot2_f32_bf16 v61, v14, v110, v61
  v_dot2_f32_bf16 v61, v15, v111, v61
  s_waitcnt vmcnt(4)
  buffer_load_dwordx4 v[36:39], v1, s[20:23], s68 offen offset:768 nt
  v_dot2_f32_bf16 v62, v16, v108, 0
  v_dot2_f32_bf16 v62, v17, v109, v62
  v_dot2_f32_bf16 v62, v18, v110, v62
  v_dot2_f32_bf16 v62, v19, v111, v62
  s_add_u32 s55, s69, 4325376
  s_waitcnt vmcnt(4)
  v_dot2_f32_bf16 v63, v20, v108, 0
  v_dot2_f32_bf16 v63, v21, v109, v63
  v_dot2_f32_bf16 v63, v22, v110, v63
  v_dot2_f32_bf16 v63, v23, v111, v63
  s_waitcnt vmcnt(3)
  buffer_load_dwordx4 v[40:43], v1, s[20:23], s68 offen offset:1024 nt
  buffer_load_dwordx4 v[44:47], v1, s[20:23], s68 offen offset:1280 nt
  v_cvt_pk_bf16_f32 v88, v56, v57
  v_cvt_pk_bf16_f32 v89, v58, v59
  v_cvt_pk_bf16_f32 v90, v60, v61
  v_cvt_pk_bf16_f32 v91, v62, v63
  v_dot2_f32_bf16 v56, v24, v108, 0
  v_dot2_f32_bf16 v56, v25, v109, v56
  v_dot2_f32_bf16 v56, v26, v110, v56
  v_dot2_f32_bf16 v56, v27, v111, v56
  s_waitcnt vmcnt(4)
  buffer_load_dwordx4 v[48:51], v1, s[20:23], s68 offen offset:1536 nt
  v_dot2_f32_bf16 v57, v28, v108, 0
  v_dot2_f32_bf16 v57, v29, v109, v57
  v_dot2_f32_bf16 v57, v30, v110, v57
  v_dot2_f32_bf16 v57, v31, v111, v57
  s_waitcnt vmcnt(4)
  buffer_load_dwordx4 v[52:55], v1, s[20:23], s68 offen offset:1792 nt
  v_dot2_f32_bf16 v58, v32, v108, 0
  v_dot2_f32_bf16 v58, v33, v109, v58
  v_dot2_f32_bf16 v58, v34, v110, v58
  v_dot2_f32_bf16 v58, v35, v111, v58
  s_waitcnt vmcnt(4)
  v_dot2_f32_bf16 v59, v36, v108, 0
  v_dot2_f32_bf16 v59, v37, v109, v59
  v_dot2_f32_bf16 v59, v38, v110, v59
  v_dot2_f32_bf16 v59, v39, v111, v59
  s_waitcnt vmcnt(3)
  buffer_load_dwordx4 v[8:11], v1, s[20:23], s55 offen offset:0 nt
  buffer_load_dwordx4 v[12:15], v1, s[20:23], s55 offen offset:256 nt
  s_waitcnt lgkmcnt(0)
  s_barrier
  v_dot2_f32_bf16 v60, v40, v108, 0
  v_dot2_f32_bf16 v60, v41, v109, v60
  v_dot2_f32_bf16 v60, v42, v110, v60
  v_dot2_f32_bf16 v60, v43, v111, v60
  ds_read_b128 a[32:35], v2 offset:32768
  ds_read_b128 a[36:39], v2 offset:40960
  s_waitcnt vmcnt(4)
  buffer_load_dwordx4 v[16:19], v1, s[20:23], s55 offen offset:512 nt
  v_dot2_f32_bf16 v61, v44, v108, 0
  v_dot2_f32_bf16 v61, v45, v109, v61
  v_dot2_f32_bf16 v61, v46, v110, v61
  v_dot2_f32_bf16 v61, v47, v111, v61
  ds_read_b128 a[40:43], v2 offset:49152
  ds_read_b128 a[44:47], v2 offset:57344
  s_waitcnt vmcnt(4)
  buffer_load_dwordx4 v[20:23], v1, s[20:23], s55 offen offset:768 nt
  v_dot2_f32_bf16 v62, v48, v108, 0
  v_dot2_f32_bf16 v62, v49, v109, v62
  v_dot2_f32_bf16 v62, v50, v110, v62
  v_dot2_f32_bf16 v62, v51, v111, v62
  ds_read_b128 a[48:51], v2 offset:33024
  ds_read_b128 a[52:55], v2 offset:41216
  s_add_u32 s68, s69, 4390912
  s_waitcnt vmcnt(4)
  v_dot2_f32_bf16 v63, v52, v108, 0
  v_dot2_f32_bf16 v63, v53, v109, v63
  v_dot2_f32_bf16 v63, v54, v110, v63
  v_dot2_f32_bf16 v63, v55, v111, v63
  ds_read_b128 a[56:59], v2 offset:49408
  ds_read_b128 a[60:63], v2 offset:57600
  s_waitcnt vmcnt(3)
  buffer_load_dwordx4 v[24:27], v1, s[20:23], s55 offen offset:1024 nt
  buffer_load_dwordx4 v[28:31], v1, s[20:23], s55 offen offset:1280 nt
  s_waitcnt lgkmcnt(0)
  v_cvt_pk_bf16_f32 v64, v56, v57
  v_cvt_pk_bf16_f32 v65, v58, v59
  v_cvt_pk_bf16_f32 v66, v60, v61
  v_cvt_pk_bf16_f32 v67, v62, v63
  v_dot2_f32_bf16 v56, v8, v112, 0
  v_dot2_f32_bf16 v56, v9, v113, v56
  v_dot2_f32_bf16 v56, v10, v114, v56
  v_dot2_f32_bf16 v56, v11, v115, v56
  v_mfma_f32_16x16x32_bf16 v[92:95], v[88:91], a[32:35], 0
  v_mfma_f32_16x16x32_bf16 v[96:99], v[88:91], a[36:39], 0
  v_mfma_f32_16x16x32_bf16 v[100:103], v[88:91], a[40:43], 0
  v_mfma_f32_16x16x32_bf16 v[104:107], v[88:91], a[44:47], 0
  v_mfma_f32_16x16x32_bf16 v[92:95], v[64:67], a[48:51], v[92:95]
  v_mfma_f32_16x16x32_bf16 v[96:99], v[64:67], a[52:55], v[96:99]
  v_mfma_f32_16x16x32_bf16 v[100:103], v[64:67], a[56:59], v[100:103]
  v_mfma_f32_16x16x32_bf16 v[104:107], v[64:67], a[60:63], v[104:107]
  s_waitcnt vmcnt(4)
  buffer_load_dwordx4 v[32:35], v1, s[20:23], s55 offen offset:1536 nt
  v_dot2_f32_bf16 v57, v12, v112, 0
  v_dot2_f32_bf16 v57, v13, v113, v57
  v_dot2_f32_bf16 v57, v14, v114, v57
  v_dot2_f32_bf16 v57, v15, v115, v57
  s_waitcnt vmcnt(4)
  buffer_load_dwordx4 v[36:39], v1, s[20:23], s55 offen offset:1792 nt
  v_dot2_f32_bf16 v58, v16, v112, 0
  v_dot2_f32_bf16 v58, v17, v113, v58
  v_dot2_f32_bf16 v58, v18, v114, v58
  v_dot2_f32_bf16 v58, v19, v115, v58
  s_waitcnt vmcnt(4)
  v_dot2_f32_bf16 v59, v20, v112, 0
  v_dot2_f32_bf16 v59, v21, v113, v59
  v_dot2_f32_bf16 v59, v22, v114, v59
  v_dot2_f32_bf16 v59, v23, v115, v59
  s_waitcnt vmcnt(3)
  buffer_load_dwordx4 v[40:43], v1, s[20:23], s68 offen offset:0 nt
  buffer_load_dwordx4 v[44:47], v1, s[20:23], s68 offen offset:256 nt
  v_dot2_f32_bf16 v60, v24, v112, 0
  v_dot2_f32_bf16 v60, v25, v113, v60
  v_dot2_f32_bf16 v60, v26, v114, v60
  v_dot2_f32_bf16 v60, v27, v115, v60
  s_waitcnt vmcnt(4)
  buffer_load_dwordx4 v[48:51], v1, s[20:23], s68 offen offset:512 nt
  v_dot2_f32_bf16 v61, v28, v112, 0
  v_dot2_f32_bf16 v61, v29, v113, v61
  v_dot2_f32_bf16 v61, v30, v114, v61
  v_dot2_f32_bf16 v61, v31, v115, v61
  s_waitcnt vmcnt(4)
  buffer_load_dwordx4 v[52:55], v1, s[20:23], s68 offen offset:768 nt
  v_dot2_f32_bf16 v62, v32, v112, 0
  v_dot2_f32_bf16 v62, v33, v113, v62
  v_dot2_f32_bf16 v62, v34, v114, v62
  v_dot2_f32_bf16 v62, v35, v115, v62
  s_add_u32 s55, s69, 262144
  s_waitcnt vmcnt(4)
  v_dot2_f32_bf16 v63, v36, v112, 0
  v_dot2_f32_bf16 v63, v37, v113, v63
  v_dot2_f32_bf16 v63, v38, v114, v63
  v_dot2_f32_bf16 v63, v39, v115, v63
  s_waitcnt vmcnt(3)
  buffer_load_dwordx4 v[8:11], v1, s[20:23], s68 offen offset:1024 nt
  buffer_load_dwordx4 v[12:15], v1, s[20:23], s68 offen offset:1280 nt
  v_cvt_pk_bf16_f32 v88, v56, v57
  v_cvt_pk_bf16_f32 v89, v58, v59
  v_cvt_pk_bf16_f32 v90, v60, v61
  v_cvt_pk_bf16_f32 v91, v62, v63
  v_dot2_f32_bf16 v56, v40, v112, 0
  v_dot2_f32_bf16 v56, v41, v113, v56
  v_dot2_f32_bf16 v56, v42, v114, v56
  v_dot2_f32_bf16 v56, v43, v115, v56
  v_mfma_f32_16x16x32_bf16 v[68:71], v[88:91], a[32:35], 0
  v_mfma_f32_16x16x32_bf16 v[72:75], v[88:91], a[36:39], 0
  v_mfma_f32_16x16x32_bf16 v[76:79], v[88:91], a[40:43], 0
  v_mfma_f32_16x16x32_bf16 v[80:83], v[88:91], a[44:47], 0
  s_waitcnt vmcnt(4)
  buffer_load_dwordx4 v[16:19], v1, s[20:23], s68 offen offset:1536 nt
  v_dot2_f32_bf16 v57, v44, v112, 0
  v_dot2_f32_bf16 v57, v45, v113, v57
  v_dot2_f32_bf16 v57, v46, v114, v57
  v_dot2_f32_bf16 v57, v47, v115, v57
  s_waitcnt vmcnt(4)
  buffer_load_dwordx4 v[20:23], v1, s[20:23], s68 offen offset:1792 nt
  v_dot2_f32_bf16 v58, v48, v112, 0
  v_dot2_f32_bf16 v58, v49, v113, v58
  v_dot2_f32_bf16 v58, v50, v114, v58
  v_dot2_f32_bf16 v58, v51, v115, v58
  s_waitcnt vmcnt(4)
  v_dot2_f32_bf16 v59, v52, v112, 0
  v_dot2_f32_bf16 v59, v53, v113, v59
  v_dot2_f32_bf16 v59, v54, v114, v59
  v_dot2_f32_bf16 v59, v55, v115, v59
  s_waitcnt vmcnt(3)
  buffer_load_dwordx4 v[24:27], v1, s[20:23], s55 offen offset:0 nt
  buffer_load_dwordx4 v[28:31], v1, s[20:23], s55 offen offset:256 nt
  v_dot2_f32_bf16 v60, v8, v112, 0
  v_dot2_f32_bf16 v60, v9, v113, v60
  v_dot2_f32_bf16 v60, v10, v114, v60
  v_dot2_f32_bf16 v60, v11, v115, v60
  s_waitcnt vmcnt(4)
  buffer_load_dwordx4 v[32:35], v1, s[20:23], s55 offen offset:512 nt
  v_dot2_f32_bf16 v61, v12, v112, 0
  v_dot2_f32_bf16 v61, v13, v113, v61
  v_dot2_f32_bf16 v61, v14, v114, v61
  v_dot2_f32_bf16 v61, v15, v115, v61
  s_waitcnt vmcnt(4)
  buffer_load_dwordx4 v[36:39], v1, s[20:23], s55 offen offset:768 nt
  v_dot2_f32_bf16 v62, v16, v112, 0
  v_dot2_f32_bf16 v62, v17, v113, v62
  v_dot2_f32_bf16 v62, v18, v114, v62
  v_dot2_f32_bf16 v62, v19, v115, v62
  s_add_u32 s68, s69, 327680
  s_waitcnt vmcnt(4)
  v_dot2_f32_bf16 v63, v20, v112, 0
  v_dot2_f32_bf16 v63, v21, v113, v63
  v_dot2_f32_bf16 v63, v22, v114, v63
  v_dot2_f32_bf16 v63, v23, v115, v63
  s_waitcnt vmcnt(3)
  buffer_load_dwordx4 v[40:43], v1, s[20:23], s55 offen offset:1024 nt
  buffer_load_dwordx4 v[44:47], v1, s[20:23], s55 offen offset:1280 nt
  v_cvt_pk_bf16_f32 v64, v56, v57
  v_cvt_pk_bf16_f32 v65, v58, v59
  v_cvt_pk_bf16_f32 v66, v60, v61
  v_cvt_pk_bf16_f32 v67, v62, v63
  v_dot2_f32_bf16 v56, v24, v108, 0
  v_dot2_f32_bf16 v56, v25, v109, v56
  v_dot2_f32_bf16 v56, v26, v110, v56
  v_dot2_f32_bf16 v56, v27, v111, v56
  v_mfma_f32_16x16x32_bf16 v[68:71], v[64:67], a[48:51], v[68:71]
  v_mfma_f32_16x16x32_bf16 v[72:75], v[64:67], a[52:55], v[72:75]
  v_mfma_f32_16x16x32_bf16 v[76:79], v[64:67], a[56:59], v[76:79]
  v_mfma_f32_16x16x32_bf16 v[80:83], v[64:67], a[60:63], v[80:83]
  s_waitcnt vmcnt(4)
  buffer_load_dwordx4 v[48:51], v1, s[20:23], s55 offen offset:1536 nt
  v_dot2_f32_bf16 v57, v28, v108, 0
  v_dot2_f32_bf16 v57, v29, v109, v57
  v_dot2_f32_bf16 v57, v30, v110, v57
  v_dot2_f32_bf16 v57, v31, v111, v57
  s_waitcnt vmcnt(4)
  buffer_load_dwordx4 v[52:55], v1, s[20:23], s55 offen offset:1792 nt
  v_dot2_f32_bf16 v58, v32, v108, 0
  v_dot2_f32_bf16 v58, v33, v109, v58
  v_dot2_f32_bf16 v58, v34, v110, v58
  v_dot2_f32_bf16 v58, v35, v111, v58
  s_waitcnt vmcnt(4)
  v_dot2_f32_bf16 v59, v36, v108, 0
  v_dot2_f32_bf16 v59, v37, v109, v59
  v_dot2_f32_bf16 v59, v38, v110, v59
  v_dot2_f32_bf16 v59, v39, v111, v59
  s_waitcnt vmcnt(3)
  buffer_load_dwordx4 v[8:11], v1, s[20:23], s68 offen offset:0 nt
  buffer_load_dwordx4 v[12:15], v1, s[20:23], s68 offen offset:256 nt
  v_dot2_f32_bf16 v60, v40, v108, 0
  v_dot2_f32_bf16 v60, v41, v109, v60
  v_dot2_f32_bf16 v60, v42, v110, v60
  v_dot2_f32_bf16 v60, v43, v111, v60
  s_waitcnt vmcnt(4)
  buffer_load_dwordx4 v[16:19], v1, s[20:23], s68 offen offset:512 nt
  v_dot2_f32_bf16 v61, v44, v108, 0
  v_dot2_f32_bf16 v61, v45, v109, v61
  v_dot2_f32_bf16 v61, v46, v110, v61
  v_dot2_f32_bf16 v61, v47, v111, v61
  s_waitcnt vmcnt(4)
  buffer_load_dwordx4 v[20:23], v1, s[20:23], s68 offen offset:768 nt
  v_dot2_f32_bf16 v62, v48, v108, 0
  v_dot2_f32_bf16 v62, v49, v109, v62
  v_dot2_f32_bf16 v62, v50, v110, v62
  v_dot2_f32_bf16 v62, v51, v111, v62
  s_add_u32 s55, s69, 4456448
  s_waitcnt vmcnt(4)
  v_dot2_f32_bf16 v63, v52, v108, 0
  v_dot2_f32_bf16 v63, v53, v109, v63
  v_dot2_f32_bf16 v63, v54, v110, v63
  v_dot2_f32_bf16 v63, v55, v111, v63
  s_waitcnt vmcnt(3)
  buffer_load_dwordx4 v[24:27], v1, s[20:23], s68 offen offset:1024 nt
  buffer_load_dwordx4 v[28:31], v1, s[20:23], s68 offen offset:1280 nt
  v_cvt_pk_bf16_f32 v88, v56, v57
  v_cvt_pk_bf16_f32 v89, v58, v59
  v_cvt_pk_bf16_f32 v90, v60, v61
  v_cvt_pk_bf16_f32 v91, v62, v63
  v_dot2_f32_bf16 v56, v8, v108, 0
  v_dot2_f32_bf16 v56, v9, v109, v56
  v_dot2_f32_bf16 v56, v10, v110, v56
  v_dot2_f32_bf16 v56, v11, v111, v56
  s_waitcnt vmcnt(4)
  buffer_load_dwordx4 v[32:35], v1, s[20:23], s68 offen offset:1536 nt
  v_dot2_f32_bf16 v57, v12, v108, 0
  v_dot2_f32_bf16 v57, v13, v109, v57
  v_dot2_f32_bf16 v57, v14, v110, v57
  v_dot2_f32_bf16 v57, v15, v111, v57
  s_waitcnt vmcnt(4)
  buffer_load_dwordx4 v[36:39], v1, s[20:23], s68 offen offset:1792 nt
  v_dot2_f32_bf16 v58, v16, v108, 0
  v_dot2_f32_bf16 v58, v17, v109, v58
  v_dot2_f32_bf16 v58, v18, v110, v58
  v_dot2_f32_bf16 v58, v19, v111, v58
  s_waitcnt vmcnt(4)
  v_dot2_f32_bf16 v59, v20, v108, 0
  v_dot2_f32_bf16 v59, v21, v109, v59
  v_dot2_f32_bf16 v59, v22, v110, v59
  v_dot2_f32_bf16 v59, v23, v111, v59
  s_waitcnt vmcnt(3)
  buffer_load_dwordx4 v[40:43], v1, s[20:23], s55 offen offset:0 nt
  buffer_load_dwordx4 v[44:47], v1, s[20:23], s55 offen offset:256 nt
  s_waitcnt lgkmcnt(0)
  s_barrier
  v_dot2_f32_bf16 v60, v24, v108, 0
  v_dot2_f32_bf16 v60, v25, v109, v60
  v_dot2_f32_bf16 v60, v26, v110, v60
  v_dot2_f32_bf16 v60, v27, v111, v60
  ds_read_b128 a[64:67], v2 offset:0
  ds_read_b128 a[68:71], v2 offset:8192
  s_waitcnt vmcnt(4)
  buffer_load_dwordx4 v[48:51], v1, s[20:23], s55 offen offset:512 nt
  v_dot2_f32_bf16 v61, v28, v108, 0
  v_dot2_f32_bf16 v61, v29, v109, v61
  v_dot2_f32_bf16 v61, v30, v110, v61
  v_dot2_f32_bf16 v61, v31, v111, v61
  ds_read_b128 a[72:75], v2 offset:16384
  ds_read_b128 a[76:79], v2 offset:24576
  s_waitcnt vmcnt(4)
  buffer_load_dwordx4 v[52:55], v1, s[20:23], s55 offen offset:768 nt
  v_dot2_f32_bf16 v62, v32, v108, 0
  v_dot2_f32_bf16 v62, v33, v109, v62
  v_dot2_f32_bf16 v62, v34, v110, v62
  v_dot2_f32_bf16 v62, v35, v111, v62
  ds_read_b128 a[80:83], v2 offset:256
  ds_read_b128 a[84:87], v2 offset:8448
  s_add_u32 s68, s69, 4521984
  s_waitcnt vmcnt(4)
  v_dot2_f32_bf16 v63, v36, v108, 0
  v_dot2_f32_bf16 v63, v37, v109, v63
  v_dot2_f32_bf16 v63, v38, v110, v63
  v_dot2_f32_bf16 v63, v39, v111, v63
  ds_read_b128 a[88:91], v2 offset:16640
  ds_read_b128 a[92:95], v2 offset:24832
  s_waitcnt vmcnt(3)
  buffer_load_dwordx4 v[8:11], v1, s[20:23], s55 offen offset:1024 nt
  buffer_load_dwordx4 v[12:15], v1, s[20:23], s55 offen offset:1280 nt
  s_waitcnt lgkmcnt(0)
  v_cvt_pk_bf16_f32 v64, v56, v57
  v_cvt_pk_bf16_f32 v65, v58, v59
  v_cvt_pk_bf16_f32 v66, v60, v61
  v_cvt_pk_bf16_f32 v67, v62, v63
  v_dot2_f32_bf16 v56, v40, v112, 0
  v_dot2_f32_bf16 v56, v41, v113, v56
  v_dot2_f32_bf16 v56, v42, v114, v56
  v_dot2_f32_bf16 v56, v43, v115, v56
  v_mfma_f32_16x16x32_bf16 v[92:95], v[88:91], a[64:67], v[92:95]
  v_mfma_f32_16x16x32_bf16 v[96:99], v[88:91], a[68:71], v[96:99]
  v_mfma_f32_16x16x32_bf16 v[100:103], v[88:91], a[72:75], v[100:103]
  v_mfma_f32_16x16x32_bf16 v[104:107], v[88:91], a[76:79], v[104:107]
  v_mfma_f32_16x16x32_bf16 v[92:95], v[64:67], a[80:83], v[92:95]
  v_mfma_f32_16x16x32_bf16 v[96:99], v[64:67], a[84:87], v[96:99]
  v_mfma_f32_16x16x32_bf16 v[100:103], v[64:67], a[88:91], v[100:103]
  v_mfma_f32_16x16x32_bf16 v[104:107], v[64:67], a[92:95], v[104:107]
  s_waitcnt vmcnt(4)
  buffer_load_dwordx4 v[16:19], v1, s[20:23], s55 offen offset:1536 nt
  v_dot2_f32_bf16 v57, v44, v112, 0
  v_dot2_f32_bf16 v57, v45, v113, v57
  v_dot2_f32_bf16 v57, v46, v114, v57
  v_dot2_f32_bf16 v57, v47, v115, v57
  s_waitcnt vmcnt(4)
  buffer_load_dwordx4 v[20:23], v1, s[20:23], s55 offen offset:1792 nt
  v_dot2_f32_bf16 v58, v48, v112, 0
  v_dot2_f32_bf16 v58, v49, v113, v58
  v_dot2_f32_bf16 v58, v50, v114, v58
  v_dot2_f32_bf16 v58, v51, v115, v58
  s_waitcnt vmcnt(4)
  v_dot2_f32_bf16 v59, v52, v112, 0
  v_dot2_f32_bf16 v59, v53, v113, v59
  v_dot2_f32_bf16 v59, v54, v114, v59
  v_dot2_f32_bf16 v59, v55, v115, v59
  s_waitcnt vmcnt(3)
  buffer_load_dwordx4 v[24:27], v1, s[20:23], s68 offen offset:0 nt
  buffer_load_dwordx4 v[28:31], v1, s[20:23], s68 offen offset:256 nt
  v_dot2_f32_bf16 v60, v8, v112, 0
  v_dot2_f32_bf16 v60, v9, v113, v60
  v_dot2_f32_bf16 v60, v10, v114, v60
  v_dot2_f32_bf16 v60, v11, v115, v60
  s_waitcnt vmcnt(4)
  buffer_load_dwordx4 v[32:35], v1, s[20:23], s68 offen offset:512 nt
  v_dot2_f32_bf16 v61, v12, v112, 0
  v_dot2_f32_bf16 v61, v13, v113, v61
  v_dot2_f32_bf16 v61, v14, v114, v61
  v_dot2_f32_bf16 v61, v15, v115, v61
  s_waitcnt vmcnt(4)
  buffer_load_dwordx4 v[36:39], v1, s[20:23], s68 offen offset:768 nt
  v_dot2_f32_bf16 v62, v16, v112, 0
  v_dot2_f32_bf16 v62, v17, v113, v62
  v_dot2_f32_bf16 v62, v18, v114, v62
  v_dot2_f32_bf16 v62, v19, v115, v62
  s_add_u32 s55, s69, 393216
  s_waitcnt vmcnt(4)
  v_dot2_f32_bf16 v63, v20, v112, 0
  v_dot2_f32_bf16 v63, v21, v113, v63
  v_dot2_f32_bf16 v63, v22, v114, v63
  v_dot2_f32_bf16 v63, v23, v115, v63
  s_waitcnt vmcnt(3)
  buffer_load_dwordx4 v[40:43], v1, s[20:23], s68 offen offset:1024 nt
  buffer_load_dwordx4 v[44:47], v1, s[20:23], s68 offen offset:1280 nt
  v_cvt_pk_bf16_f32 v88, v56, v57
  v_cvt_pk_bf16_f32 v89, v58, v59
  v_cvt_pk_bf16_f32 v90, v60, v61
  v_cvt_pk_bf16_f32 v91, v62, v63
  v_dot2_f32_bf16 v56, v24, v112, 0
  v_dot2_f32_bf16 v56, v25, v113, v56
  v_dot2_f32_bf16 v56, v26, v114, v56
  v_dot2_f32_bf16 v56, v27, v115, v56
  v_mfma_f32_16x16x32_bf16 v[68:71], v[88:91], a[64:67], v[68:71]
  v_mfma_f32_16x16x32_bf16 v[72:75], v[88:91], a[68:71], v[72:75]
  v_mfma_f32_16x16x32_bf16 v[76:79], v[88:91], a[72:75], v[76:79]
  v_mfma_f32_16x16x32_bf16 v[80:83], v[88:91], a[76:79], v[80:83]
  s_waitcnt vmcnt(4)
  buffer_load_dwordx4 v[48:51], v1, s[20:23], s68 offen offset:1536 nt
  v_dot2_f32_bf16 v57, v28, v112, 0
  v_dot2_f32_bf16 v57, v29, v113, v57
  v_dot2_f32_bf16 v57, v30, v114, v57
  v_dot2_f32_bf16 v57, v31, v115, v57
  s_waitcnt vmcnt(4)
  buffer_load_dwordx4 v[52:55], v1, s[20:23], s68 offen offset:1792 nt
  v_dot2_f32_bf16 v58, v32, v112, 0
  v_dot2_f32_bf16 v58, v33, v113, v58
  v_dot2_f32_bf16 v58, v34, v114, v58
  v_dot2_f32_bf16 v58, v35, v115, v58
  s_waitcnt vmcnt(4)
  v_dot2_f32_bf16 v59, v36, v112, 0
  v_dot2_f32_bf16 v59, v37, v113, v59
  v_dot2_f32_bf16 v59, v38, v114, v59
  v_dot2_f32_bf16 v59, v39, v115, v59
  s_waitcnt vmcnt(3)
  buffer_load_dwordx4 v[8:11], v1, s[20:23], s55 offen offset:0 nt
  buffer_load_dwordx4 v[12:15], v1, s[20:23], s55 offen offset:256 nt
  v_dot2_f32_bf16 v60, v40, v112, 0
  v_dot2_f32_bf16 v60, v41, v113, v60
  v_dot2_f32_bf16 v60, v42, v114, v60
  v_dot2_f32_bf16 v60, v43, v115, v60
  s_waitcnt vmcnt(4)
  buffer_load_dwordx4 v[16:19], v1, s[20:23], s55 offen offset:512 nt
  v_dot2_f32_bf16 v61, v44, v112, 0
  v_dot2_f32_bf16 v61, v45, v113, v61
  v_dot2_f32_bf16 v61, v46, v114, v61
  v_dot2_f32_bf16 v61, v47, v115, v61
  s_waitcnt vmcnt(4)
  buffer_load_dwordx4 v[20:23], v1, s[20:23], s55 offen offset:768 nt
  v_dot2_f32_bf16 v62, v48, v112, 0
  v_dot2_f32_bf16 v62, v49, v113, v62
  v_dot2_f32_bf16 v62, v50, v114, v62
  v_dot2_f32_bf16 v62, v51, v115, v62
  s_add_u32 s68, s69, 458752
  s_waitcnt vmcnt(4)
  v_dot2_f32_bf16 v63, v52, v112, 0
  v_dot2_f32_bf16 v63, v53, v113, v63
  v_dot2_f32_bf16 v63, v54, v114, v63
  v_dot2_f32_bf16 v63, v55, v115, v63
  s_waitcnt vmcnt(3)
  buffer_load_dwordx4 v[24:27], v1, s[20:23], s55 offen offset:1024 nt
  buffer_load_dwordx4 v[28:31], v1, s[20:23], s55 offen offset:1280 nt
  v_cvt_pk_bf16_f32 v64, v56, v57
  v_cvt_pk_bf16_f32 v65, v58, v59
  v_cvt_pk_bf16_f32 v66, v60, v61
  v_cvt_pk_bf16_f32 v67, v62, v63
  v_dot2_f32_bf16 v56, v8, v108, 0
  v_dot2_f32_bf16 v56, v9, v109, v56
  v_dot2_f32_bf16 v56, v10, v110, v56
  v_dot2_f32_bf16 v56, v11, v111, v56
  v_mfma_f32_16x16x32_bf16 v[68:71], v[64:67], a[80:83], v[68:71]
  v_mfma_f32_16x16x32_bf16 v[72:75], v[64:67], a[84:87], v[72:75]
  v_mfma_f32_16x16x32_bf16 v[76:79], v[64:67], a[88:91], v[76:79]
  v_mfma_f32_16x16x32_bf16 v[80:83], v[64:67], a[92:95], v[80:83]
  s_waitcnt vmcnt(4)
  buffer_load_dwordx4 v[32:35], v1, s[20:23], s55 offen offset:1536 nt
  v_dot2_f32_bf16 v57, v12, v108, 0
  v_dot2_f32_bf16 v57, v13, v109, v57
  v_dot2_f32_bf16 v57, v14, v110, v57
  v_dot2_f32_bf16 v57, v15, v111, v57
  s_waitcnt vmcnt(4)
  buffer_load_dwordx4 v[36:39], v1, s[20:23], s55 offen offset:1792 nt
  v_dot2_f32_bf16 v58, v16, v108, 0
  v_dot2_f32_bf16 v58, v17, v109, v58
  v_dot2_f32_bf16 v58, v18, v110, v58
  v_dot2_f32_bf16 v58, v19, v111, v58
  s_waitcnt vmcnt(4)
  v_dot2_f32_bf16 v59, v20, v108, 0
  v_dot2_f32_bf16 v59, v21, v109, v59
  v_dot2_f32_bf16 v59, v22, v110, v59
  v_dot2_f32_bf16 v59, v23, v111, v59
  s_waitcnt vmcnt(3)
  buffer_load_dwordx4 v[40:43], v1, s[20:23], s68 offen offset:0 nt
  buffer_load_dwordx4 v[44:47], v1, s[20:23], s68 offen offset:256 nt
  v_dot2_f32_bf16 v60, v24, v108, 0
  v_dot2_f32_bf16 v60, v25, v109, v60
  v_dot2_f32_bf16 v60, v26, v110, v60
  v_dot2_f32_bf16 v60, v27, v111, v60
  s_waitcnt vmcnt(4)
  buffer_load_dwordx4 v[48:51], v1, s[20:23], s68 offen offset:512 nt
  v_dot2_f32_bf16 v61, v28, v108, 0
  v_dot2_f32_bf16 v61, v29, v109, v61
  v_dot2_f32_bf16 v61, v30, v110, v61
  v_dot2_f32_bf16 v61, v31, v111, v61
  s_waitcnt vmcnt(4)
  buffer_load_dwordx4 v[52:55], v1, s[20:23], s68 offen offset:768 nt
  v_dot2_f32_bf16 v62, v32, v108, 0
  v_dot2_f32_bf16 v62, v33, v109, v62
  v_dot2_f32_bf16 v62, v34, v110, v62
  v_dot2_f32_bf16 v62, v35, v111, v62
  s_add_u32 s55, s69, 4587520
  s_waitcnt vmcnt(4)
  v_dot2_f32_bf16 v63, v36, v108, 0
  v_dot2_f32_bf16 v63, v37, v109, v63
  v_dot2_f32_bf16 v63, v38, v110, v63
  v_dot2_f32_bf16 v63, v39, v111, v63
  s_waitcnt vmcnt(3)
  buffer_load_dwordx4 v[8:11], v1, s[20:23], s68 offen offset:1024 nt
  buffer_load_dwordx4 v[12:15], v1, s[20:23], s68 offen offset:1280 nt
  v_cvt_pk_bf16_f32 v88, v56, v57
  v_cvt_pk_bf16_f32 v89, v58, v59
  v_cvt_pk_bf16_f32 v90, v60, v61
  v_cvt_pk_bf16_f32 v91, v62, v63
  v_dot2_f32_bf16 v56, v40, v108, 0
  v_dot2_f32_bf16 v56, v41, v109, v56
  v_dot2_f32_bf16 v56, v42, v110, v56
  v_dot2_f32_bf16 v56, v43, v111, v56
  buffer_load_dwordx4 v[116:119], v6, s[36:39], s57 offen offset:1024 nt
  s_waitcnt vmcnt(5)
  buffer_load_dwordx4 v[16:19], v1, s[20:23], s68 offen offset:1536 nt
  v_dot2_f32_bf16 v57, v44, v108, 0
  v_dot2_f32_bf16 v57, v45, v109, v57
  v_dot2_f32_bf16 v57, v46, v110, v57
  v_dot2_f32_bf16 v57, v47, v111, v57
  s_waitcnt vmcnt(5)
  buffer_load_dwordx4 v[20:23], v1, s[20:23], s68 offen offset:1792 nt
  v_dot2_f32_bf16 v58, v48, v108, 0
  v_dot2_f32_bf16 v58, v49, v109, v58
  v_dot2_f32_bf16 v58, v50, v110, v58
  v_dot2_f32_bf16 v58, v51, v111, v58
  buffer_load_dwordx4 v[84:87], v6, s[36:39], s57 offen offset:1536 nt
  s_waitcnt vmcnt(6)
  v_dot2_f32_bf16 v59, v52, v108, 0
  v_dot2_f32_bf16 v59, v53, v109, v59
  v_dot2_f32_bf16 v59, v54, v110, v59
  v_dot2_f32_bf16 v59, v55, v111, v59
  s_waitcnt vmcnt(5)
  buffer_load_dwordx4 v[24:27], v1, s[20:23], s55 offen offset:0 nt
  buffer_load_dwordx4 v[28:31], v1, s[20:23], s55 offen offset:256 nt
  s_waitcnt lgkmcnt(0)
  s_barrier
  v_dot2_f32_bf16 v60, v8, v108, 0
  v_dot2_f32_bf16 v60, v9, v109, v60
  v_dot2_f32_bf16 v60, v10, v110, v60
  v_dot2_f32_bf16 v60, v11, v111, v60
  ds_read_b128 a[96:99], v2 offset:32768
  ds_read_b128 a[100:103], v2 offset:40960
  s_waitcnt vmcnt(6)
  buffer_load_dwordx4 v[32:35], v1, s[20:23], s55 offen offset:512 nt
  v_dot2_f32_bf16 v61, v12, v108, 0
  v_dot2_f32_bf16 v61, v13, v109, v61
  v_dot2_f32_bf16 v61, v14, v110, v61
  v_dot2_f32_bf16 v61, v15, v111, v61
  ds_read_b128 a[104:107], v2 offset:49152
  ds_read_b128 a[108:111], v2 offset:57344
  s_waitcnt vmcnt(5)
  buffer_load_dwordx4 v[36:39], v1, s[20:23], s55 offen offset:768 nt
  v_dot2_f32_bf16 v62, v16, v108, 0
  v_dot2_f32_bf16 v62, v17, v109, v62
  v_dot2_f32_bf16 v62, v18, v110, v62
  v_dot2_f32_bf16 v62, v19, v111, v62
  ds_read_b128 a[112:115], v2 offset:33024
  ds_read_b128 a[116:119], v2 offset:41216
  s_add_u32 s68, s69, 4653056
  s_waitcnt vmcnt(5)
  v_dot2_f32_bf16 v63, v20, v108, 0
  v_dot2_f32_bf16 v63, v21, v109, v63
  v_dot2_f32_bf16 v63, v22, v110, v63
  v_dot2_f32_bf16 v63, v23, v111, v63
  ds_read_b128 a[120:123], v2 offset:49408
  ds_read_b128 a[124:127], v2 offset:57600
  s_waitcnt vmcnt(3)
  buffer_load_dwordx4 v[40:43], v1, s[20:23], s55 offen offset:1024 nt
  buffer_load_dwordx4 v[44:47], v1, s[20:23], s55 offen offset:1280 nt
  s_waitcnt lgkmcnt(0)
  v_cvt_pk_bf16_f32 v64, v56, v57
  v_cvt_pk_bf16_f32 v65, v58, v59
  v_cvt_pk_bf16_f32 v66, v60, v61
  v_cvt_pk_bf16_f32 v67, v62, v63
  v_dot2_f32_bf16 v56, v24, v112, 0
  v_dot2_f32_bf16 v56, v25, v113, v56
  v_dot2_f32_bf16 v56, v26, v114, v56
  v_dot2_f32_bf16 v56, v27, v115, v56
  v_mfma_f32_16x16x32_bf16 v[92:95], v[88:91], a[96:99], v[92:95]
  v_mfma_f32_16x16x32_bf16 v[96:99], v[88:91], a[100:103], v[96:99]
  v_mfma_f32_16x16x32_bf16 v[100:103], v[88:91], a[104:107], v[100:103]
  v_mfma_f32_16x16x32_bf16 v[104:107], v[88:91], a[108:111], v[104:107]
  v_mfma_f32_16x16x32_bf16 v[92:95], v[64:67], a[112:115], v[92:95]
  v_mfma_f32_16x16x32_bf16 v[96:99], v[64:67], a[116:119], v[96:99]
  v_mfma_f32_16x16x32_bf16 v[100:103], v[64:67], a[120:123], v[100:103]
  v_mfma_f32_16x16x32_bf16 v[104:107], v[64:67], a[124:127], v[104:107]
  s_waitcnt vmcnt(4)
  buffer_load_dwordx4 v[48:51], v1, s[20:23], s55 offen offset:1536 nt
  v_dot2_f32_bf16 v57, v28, v112, 0
  v_dot2_f32_bf16 v57, v29, v113, v57
  v_dot2_f32_bf16 v57, v30, v114, v57
  v_dot2_f32_bf16 v57, v31, v115, v57
  v_add_f32 v92, v92, v93
  v_add_f32 v96, v96, v97
  v_add_f32 v100, v100, v101
  v_add_f32 v104, v104, v105
  v_add_f32 v94, v94, v95
  v_add_f32 v98, v98, v99
  v_add_f32 v102, v102, v103
  v_add_f32 v106, v106, v107
  v_add_f32 v92, v92, v94
  v_add_f32 v96, v96, v98
  v_add_f32 v100, v100, v102
  v_add_f32 v104, v104, v106
  ds_write_b32 v3, v92 offset:0
  ds_write_b32 v3, v96 offset:1024
  ds_write_b32 v3, v100 offset:2048
  ds_write_b32 v3, v104 offset:3072
  s_waitcnt vmcnt(4)
  buffer_load_dwordx4 v[52:55], v1, s[20:23], s55 offen offset:1792 nt
  v_dot2_f32_bf16 v58, v32, v112, 0
  v_dot2_f32_bf16 v58, v33, v113, v58
  v_dot2_f32_bf16 v58, v34, v114, v58
  v_dot2_f32_bf16 v58, v35, v115, v58
  s_waitcnt vmcnt(4)
  v_dot2_f32_bf16 v59, v36, v112, 0
  v_dot2_f32_bf16 v59, v37, v113, v59
  v_dot2_f32_bf16 v59, v38, v114, v59
  v_dot2_f32_bf16 v59, v39, v115, v59
  s_waitcnt vmcnt(3)
  buffer_load_dwordx4 v[8:11], v1, s[20:23], s68 offen offset:0 nt
  buffer_load_dwordx4 v[12:15], v1, s[20:23], s68 offen offset:256 nt
  v_dot2_f32_bf16 v60, v40, v112, 0
  v_dot2_f32_bf16 v60, v41, v113, v60
  v_dot2_f32_bf16 v60, v42, v114, v60
  v_dot2_f32_bf16 v60, v43, v115, v60
  s_waitcnt vmcnt(4)
  buffer_load_dwordx4 v[16:19], v1, s[20:23], s68 offen offset:512 nt
  v_dot2_f32_bf16 v61, v44, v112, 0
  v_dot2_f32_bf16 v61, v45, v113, v61
  v_dot2_f32_bf16 v61, v46, v114, v61
  v_dot2_f32_bf16 v61, v47, v115, v61
  s_waitcnt vmcnt(4)
  buffer_load_dwordx4 v[20:23], v1, s[20:23], s68 offen offset:768 nt
  v_dot2_f32_bf16 v62, v48, v112, 0
  v_dot2_f32_bf16 v62, v49, v113, v62
  v_dot2_f32_bf16 v62, v50, v114, v62
  v_dot2_f32_bf16 v62, v51, v115, v62
  s_add_u32 s55, s69, 8388608
  s_waitcnt vmcnt(4)
  v_dot2_f32_bf16 v63, v52, v112, 0
  v_dot2_f32_bf16 v63, v53, v113, v63
  v_dot2_f32_bf16 v63, v54, v114, v63
  v_dot2_f32_bf16 v63, v55, v115, v63
  s_waitcnt vmcnt(3)
  buffer_load_dwordx4 v[24:27], v1, s[20:23], s68 offen offset:1024 nt
  buffer_load_dwordx4 v[28:31], v1, s[20:23], s68 offen offset:1280 nt
  v_cvt_pk_bf16_f32 v88, v56, v57
  v_cvt_pk_bf16_f32 v89, v58, v59
  v_cvt_pk_bf16_f32 v90, v60, v61
  v_cvt_pk_bf16_f32 v91, v62, v63
  v_dot2_f32_bf16 v56, v8, v112, 0
  v_dot2_f32_bf16 v56, v9, v113, v56
  v_dot2_f32_bf16 v56, v10, v114, v56
  v_dot2_f32_bf16 v56, v11, v115, v56
  v_mfma_f32_16x16x32_bf16 v[68:71], v[88:91], a[96:99], v[68:71]
  v_mfma_f32_16x16x32_bf16 v[72:75], v[88:91], a[100:103], v[72:75]
  v_mfma_f32_16x16x32_bf16 v[76:79], v[88:91], a[104:107], v[76:79]
  v_mfma_f32_16x16x32_bf16 v[80:83], v[88:91], a[108:111], v[80:83]
  s_waitcnt vmcnt(4)
  buffer_load_dwordx4 v[32:35], v1, s[20:23], s68 offen offset:1536 nt
  v_dot2_f32_bf16 v57, v12, v112, 0
  v_dot2_f32_bf16 v57, v13, v113, v57
  v_dot2_f32_bf16 v57, v14, v114, v57
  v_dot2_f32_bf16 v57, v15, v115, v57
  s_waitcnt vmcnt(4)
  buffer_load_dwordx4 v[36:39], v1, s[20:23], s68 offen offset:1792 nt
  v_dot2_f32_bf16 v58, v16, v112, 0
  v_dot2_f32_bf16 v58, v17, v113, v58
  v_dot2_f32_bf16 v58, v18, v114, v58
  v_dot2_f32_bf16 v58, v19, v115, v58
  s_waitcnt vmcnt(4)
  v_dot2_f32_bf16 v59, v20, v112, 0
  v_dot2_f32_bf16 v59, v21, v113, v59
  v_dot2_f32_bf16 v59, v22, v114, v59
  v_dot2_f32_bf16 v59, v23, v115, v59
  s_waitcnt vmcnt(3)
  buffer_load_dwordx4 v[40:43], v1, s[20:23], s55 offen offset:0 nt
  buffer_load_dwordx4 v[44:47], v1, s[20:23], s55 offen offset:256 nt
  v_dot2_f32_bf16 v60, v24, v112, 0
  v_dot2_f32_bf16 v60, v25, v113, v60
  v_dot2_f32_bf16 v60, v26, v114, v60
  v_dot2_f32_bf16 v60, v27, v115, v60
  s_waitcnt vmcnt(4)
  buffer_load_dwordx4 v[48:51], v1, s[20:23], s55 offen offset:512 nt
  v_dot2_f32_bf16 v61, v28, v112, 0
  v_dot2_f32_bf16 v61, v29, v113, v61
  v_dot2_f32_bf16 v61, v30, v114, v61
  v_dot2_f32_bf16 v61, v31, v115, v61
  s_waitcnt vmcnt(4)
  buffer_load_dwordx4 v[52:55], v1, s[20:23], s55 offen offset:768 nt
  v_dot2_f32_bf16 v62, v32, v112, 0
  v_dot2_f32_bf16 v62, v33, v113, v62
  v_dot2_f32_bf16 v62, v34, v114, v62
  v_dot2_f32_bf16 v62, v35, v115, v62
  s_add_u32 s68, s69, 8454144
  s_waitcnt vmcnt(4)
  v_dot2_f32_bf16 v63, v36, v112, 0
  v_dot2_f32_bf16 v63, v37, v113, v63
  v_dot2_f32_bf16 v63, v38, v114, v63
  v_dot2_f32_bf16 v63, v39, v115, v63
  s_waitcnt vmcnt(3)
  buffer_load_dwordx4 v[8:11], v1, s[20:23], s55 offen offset:1024 nt
  buffer_load_dwordx4 v[12:15], v1, s[20:23], s55 offen offset:1280 nt
  v_cvt_pk_bf16_f32 v64, v56, v57
  v_cvt_pk_bf16_f32 v65, v58, v59
  v_cvt_pk_bf16_f32 v66, v60, v61
  v_cvt_pk_bf16_f32 v67, v62, v63
  v_dot2_f32_bf16 v56, v40, v116, 0
  v_dot2_f32_bf16 v56, v41, v117, v56
  v_dot2_f32_bf16 v56, v42, v118, v56
  v_dot2_f32_bf16 v56, v43, v119, v56
  v_mfma_f32_16x16x32_bf16 v[68:71], v[64:67], a[112:115], v[68:71]
  v_mfma_f32_16x16x32_bf16 v[72:75], v[64:67], a[116:119], v[72:75]
  v_mfma_f32_16x16x32_bf16 v[76:79], v[64:67], a[120:123], v[76:79]
  v_mfma_f32_16x16x32_bf16 v[80:83], v[64:67], a[124:127], v[80:83]
  s_waitcnt vmcnt(4)
  buffer_load_dwordx4 v[16:19], v1, s[20:23], s55 offen offset:1536 nt
  v_dot2_f32_bf16 v57, v44, v116, 0
  v_dot2_f32_bf16 v57, v45, v117, v57
  v_dot2_f32_bf16 v57, v46, v118, v57
  v_dot2_f32_bf16 v57, v47, v119, v57
  v_add_f32 v68, v68, v69
  v_add_f32 v72, v72, v73
  v_add_f32 v76, v76, v77
  v_add_f32 v80, v80, v81
  v_add_f32 v70, v70, v71
  v_add_f32 v74, v74, v75
  v_add_f32 v78, v78, v79
  v_add_f32 v82, v82, v83
  v_add_f32 v68, v68, v70
  v_add_f32 v72, v72, v74
  v_add_f32 v76, v76, v78
  v_add_f32 v80, v80, v82
  ds_write_b32 v3, v68 offset:4096
  ds_write_b32 v3, v72 offset:5120
  ds_write_b32 v3, v76 offset:6144
  ds_write_b32 v3, v80 offset:7168
  s_waitcnt vmcnt(4)
  buffer_load_dwordx4 v[20:23], v1, s[20:23], s55 offen offset:1792 nt
  s_waitcnt lgkmcnt(0)
  s_barrier
  v_dot2_f32_bf16 v58, v48, v116, 0
  v_dot2_f32_bf16 v58, v49, v117, v58
  v_dot2_f32_bf16 v58, v50, v118, v58
  v_dot2_f32_bf16 v58, v51, v119, v58
  ds_read_b128 a[0:3], v2 offset:0
  ds_read_b128 a[4:7], v2 offset:8192
  s_waitcnt vmcnt(4)
  v_dot2_f32_bf16 v59, v52, v116, 0
  v_dot2_f32_bf16 v59, v53, v117, v59
  v_dot2_f32_bf16 v59, v54, v118, v59
  v_dot2_f32_bf16 v59, v55, v119, v59
  ds_read_b128 a[8:11], v2 offset:16384
  ds_read_b128 a[12:15], v2 offset:24576
  s_waitcnt vmcnt(3)
  buffer_load_dwordx4 v[24:27], v1, s[20:23], s68 offen offset:0 nt
  buffer_load_dwordx4 v[28:31], v1, s[20:23], s68 offen offset:256 nt
  v_dot2_f32_bf16 v60, v8, v116, 0
  v_dot2_f32_bf16 v60, v9, v117, v60
  v_dot2_f32_bf16 v60, v10, v118, v60
  v_dot2_f32_bf16 v60, v11, v119, v60
  ds_read_b128 a[16:19], v2 offset:256
  ds_read_b128 a[20:23], v2 offset:8448
  s_waitcnt vmcnt(4)
  buffer_load_dwordx4 v[32:35], v1, s[20:23], s68 offen offset:512 nt
  v_dot2_f32_bf16 v61, v12, v116, 0
  v_dot2_f32_bf16 v61, v13, v117, v61
  v_dot2_f32_bf16 v61, v14, v118, v61
  v_dot2_f32_bf16 v61, v15, v119, v61
  ds_read_b128 a[24:27], v2 offset:16640
  ds_read_b128 a[28:31], v2 offset:24832
  s_waitcnt vmcnt(4)
  buffer_load_dwordx4 v[36:39], v1, s[20:23], s68 offen offset:768 nt
  v_dot2_f32_bf16 v62, v16, v116, 0
  v_dot2_f32_bf16 v62, v17, v117, v62
  v_dot2_f32_bf16 v62, v18, v118, v62
  v_dot2_f32_bf16 v62, v19, v119, v62
  s_add_u32 s55, s69, 12582912
  s_waitcnt vmcnt(4)
  v_dot2_f32_bf16 v63, v20, v116, 0
  v_dot2_f32_bf16 v63, v21, v117, v63
  v_dot2_f32_bf16 v63, v22, v118, v63
  v_dot2_f32_bf16 v63, v23, v119, v63
  s_waitcnt vmcnt(3)
  buffer_load_dwordx4 v[40:43], v1, s[20:23], s68 offen offset:1024 nt
  buffer_load_dwordx4 v[44:47], v1, s[20:23], s68 offen offset:1280 nt
  s_waitcnt lgkmcnt(0)
  v_cvt_pk_bf16_f32 v88, v56, v57
  v_cvt_pk_bf16_f32 v89, v58, v59
  v_cvt_pk_bf16_f32 v90, v60, v61
  v_cvt_pk_bf16_f32 v91, v62, v63
  v_dot2_f32_bf16 v56, v24, v116, 0
  v_dot2_f32_bf16 v56, v25, v117, v56
  v_dot2_f32_bf16 v56, v26, v118, v56
  v_dot2_f32_bf16 v56, v27, v119, v56
  v_mfma_f32_16x16x32_bf16 v[92:95], v[88:91], a[0:3], 0
  v_mfma_f32_16x16x32_bf16 v[96:99], v[88:91], a[4:7], 0
  v_mfma_f32_16x16x32_bf16 v[100:103], v[88:91], a[8:11], 0
  v_mfma_f32_16x16x32_bf16 v[104:107], v[88:91], a[12:15], 0
  s_waitcnt vmcnt(4)
  buffer_load_dwordx4 v[48:51], v1, s[20:23], s68 offen offset:1536 nt
  v_dot2_f32_bf16 v57, v28, v116, 0
  v_dot2_f32_bf16 v57, v29, v117, v57
  v_dot2_f32_bf16 v57, v30, v118, v57
  v_dot2_f32_bf16 v57, v31, v119, v57
  s_waitcnt vmcnt(4)
  buffer_load_dwordx4 v[52:55], v1, s[20:23], s68 offen offset:1792 nt
  v_dot2_f32_bf16 v58, v32, v116, 0
  v_dot2_f32_bf16 v58, v33, v117, v58
  v_dot2_f32_bf16 v58, v34, v118, v58
  v_dot2_f32_bf16 v58, v35, v119, v58
  s_waitcnt vmcnt(4)
  v_dot2_f32_bf16 v59, v36, v116, 0
  v_dot2_f32_bf16 v59, v37, v117, v59
  v_dot2_f32_bf16 v59, v38, v118, v59
  v_dot2_f32_bf16 v59, v39, v119, v59
  s_waitcnt vmcnt(3)
  buffer_load_dwordx4 v[8:11], v1, s[20:23], s55 offen offset:0 nt
  buffer_load_dwordx4 v[12:15], v1, s[20:23], s55 offen offset:256 nt
  v_dot2_f32_bf16 v60, v40, v116, 0
  v_dot2_f32_bf16 v60, v41, v117, v60
  v_dot2_f32_bf16 v60, v42, v118, v60
  v_dot2_f32_bf16 v60, v43, v119, v60
  s_waitcnt vmcnt(4)
  buffer_load_dwordx4 v[16:19], v1, s[20:23], s55 offen offset:512 nt
  v_dot2_f32_bf16 v61, v44, v116, 0
  v_dot2_f32_bf16 v61, v45, v117, v61
  v_dot2_f32_bf16 v61, v46, v118, v61
  v_dot2_f32_bf16 v61, v47, v119, v61
  s_waitcnt vmcnt(4)
  buffer_load_dwordx4 v[20:23], v1, s[20:23], s55 offen offset:768 nt
  v_dot2_f32_bf16 v62, v48, v116, 0
  v_dot2_f32_bf16 v62, v49, v117, v62
  v_dot2_f32_bf16 v62, v50, v118, v62
  v_dot2_f32_bf16 v62, v51, v119, v62
  s_add_u32 s68, s69, 12648448
  s_waitcnt vmcnt(4)
  v_dot2_f32_bf16 v63, v52, v116, 0
  v_dot2_f32_bf16 v63, v53, v117, v63
  v_dot2_f32_bf16 v63, v54, v118, v63
  v_dot2_f32_bf16 v63, v55, v119, v63
  s_waitcnt vmcnt(3)
  buffer_load_dwordx4 v[24:27], v1, s[20:23], s55 offen offset:1024 nt
  buffer_load_dwordx4 v[28:31], v1, s[20:23], s55 offen offset:1280 nt
  v_cvt_pk_bf16_f32 v64, v56, v57
  v_cvt_pk_bf16_f32 v65, v58, v59
  v_cvt_pk_bf16_f32 v66, v60, v61
  v_cvt_pk_bf16_f32 v67, v62, v63
  v_dot2_f32_bf16 v56, v8, v84, 0
  v_dot2_f32_bf16 v56, v9, v85, v56
  v_dot2_f32_bf16 v56, v10, v86, v56
  v_dot2_f32_bf16 v56, v11, v87, v56
  v_mfma_f32_16x16x32_bf16 v[92:95], v[64:67], a[16:19], v[92:95]
  v_mfma_f32_16x16x32_bf16 v[96:99], v[64:67], a[20:23], v[96:99]
  v_mfma_f32_16x16x32_bf16 v[100:103], v[64:67], a[24:27], v[100:103]
  v_mfma_f32_16x16x32_bf16 v[104:107], v[64:67], a[28:31], v[104:107]
  s_waitcnt vmcnt(4)
  buffer_load_dwordx4 v[32:35], v1, s[20:23], s55 offen offset:1536 nt
  v_dot2_f32_bf16 v57, v12, v84, 0
  v_dot2_f32_bf16 v57, v13, v85, v57
  v_dot2_f32_bf16 v57, v14, v86, v57
  v_dot2_f32_bf16 v57, v15, v87, v57
  s_waitcnt vmcnt(4)
  buffer_load_dwordx4 v[36:39], v1, s[20:23], s55 offen offset:1792 nt
  v_dot2_f32_bf16 v58, v16, v84, 0
  v_dot2_f32_bf16 v58, v17, v85, v58
  v_dot2_f32_bf16 v58, v18, v86, v58
  v_dot2_f32_bf16 v58, v19, v87, v58
  s_waitcnt vmcnt(4)
  v_dot2_f32_bf16 v59, v20, v84, 0
  v_dot2_f32_bf16 v59, v21, v85, v59
  v_dot2_f32_bf16 v59, v22, v86, v59
  v_dot2_f32_bf16 v59, v23, v87, v59
  s_waitcnt vmcnt(3)
  buffer_load_dwordx4 v[40:43], v1, s[20:23], s68 offen offset:0 nt
  buffer_load_dwordx4 v[44:47], v1, s[20:23], s68 offen offset:256 nt
  v_dot2_f32_bf16 v60, v24, v84, 0
  v_dot2_f32_bf16 v60, v25, v85, v60
  v_dot2_f32_bf16 v60, v26, v86, v60
  v_dot2_f32_bf16 v60, v27, v87, v60
  s_waitcnt vmcnt(4)
  buffer_load_dwordx4 v[48:51], v1, s[20:23], s68 offen offset:512 nt
  v_dot2_f32_bf16 v61, v28, v84, 0
  v_dot2_f32_bf16 v61, v29, v85, v61
  v_dot2_f32_bf16 v61, v30, v86, v61
  v_dot2_f32_bf16 v61, v31, v87, v61
  s_waitcnt vmcnt(4)
  buffer_load_dwordx4 v[52:55], v1, s[20:23], s68 offen offset:768 nt
  v_dot2_f32_bf16 v62, v32, v84, 0
  v_dot2_f32_bf16 v62, v33, v85, v62
  v_dot2_f32_bf16 v62, v34, v86, v62
  v_dot2_f32_bf16 v62, v35, v87, v62
  s_add_u32 s55, s69, 8519680
  s_waitcnt vmcnt(4)
  v_dot2_f32_bf16 v63, v36, v84, 0
  v_dot2_f32_bf16 v63, v37, v85, v63
  v_dot2_f32_bf16 v63, v38, v86, v63
  v_dot2_f32_bf16 v63, v39, v87, v63
  s_waitcnt vmcnt(3)
  buffer_load_dwordx4 v[8:11], v1, s[20:23], s68 offen offset:1024 nt
  buffer_load_dwordx4 v[12:15], v1, s[20:23], s68 offen offset:1280 nt
  v_cvt_pk_bf16_f32 v88, v56, v57
  v_cvt_pk_bf16_f32 v89, v58, v59
  v_cvt_pk_bf16_f32 v90, v60, v61
  v_cvt_pk_bf16_f32 v91, v62, v63
  v_dot2_f32_bf16 v56, v40, v84, 0
  v_dot2_f32_bf16 v56, v41, v85, v56
  v_dot2_f32_bf16 v56, v42, v86, v56
  v_dot2_f32_bf16 v56, v43, v87, v56
  v_mfma_f32_16x16x32_bf16 v[68:71], v[88:91], a[0:3], 0
  v_mfma_f32_16x16x32_bf16 v[72:75], v[88:91], a[4:7], 0
  v_mfma_f32_16x16x32_bf16 v[76:79], v[88:91], a[8:11], 0
  v_mfma_f32_16x16x32_bf16 v[80:83], v[88:91], a[12:15], 0
  s_waitcnt vmcnt(4)
  buffer_load_dwordx4 v[16:19], v1, s[20:23], s68 offen offset:1536 nt
  v_dot2_f32_bf16 v57, v44, v84, 0
  v_dot2_f32_bf16 v57, v45, v85, v57
  v_dot2_f32_bf16 v57, v46, v86, v57
  v_dot2_f32_bf16 v57, v47, v87, v57
  s_waitcnt vmcnt(4)
  buffer_load_dwordx4 v[20:23], v1, s[20:23], s68 offen offset:1792 nt
  v_dot2_f32_bf16 v58, v48, v84, 0
  v_dot2_f32_bf16 v58, v49, v85, v58
  v_dot2_f32_bf16 v58, v50, v86, v58
  v_dot2_f32_bf16 v58, v51, v87, v58
  s_waitcnt vmcnt(4)
  v_dot2_f32_bf16 v59, v52, v84, 0
  v_dot2_f32_bf16 v59, v53, v85, v59
  v_dot2_f32_bf16 v59, v54, v86, v59
  v_dot2_f32_bf16 v59, v55, v87, v59
  s_waitcnt vmcnt(3)
  buffer_load_dwordx4 v[24:27], v1, s[20:23], s55 offen offset:0 nt
  buffer_load_dwordx4 v[28:31], v1, s[20:23], s55 offen offset:256 nt
  v_dot2_f32_bf16 v60, v8, v84, 0
  v_dot2_f32_bf16 v60, v9, v85, v60
  v_dot2_f32_bf16 v60, v10, v86, v60
  v_dot2_f32_bf16 v60, v11, v87, v60
  s_waitcnt vmcnt(4)
  buffer_load_dwordx4 v[32:35], v1, s[20:23], s55 offen offset:512 nt
  v_dot2_f32_bf16 v61, v12, v84, 0
  v_dot2_f32_bf16 v61, v13, v85, v61
  v_dot2_f32_bf16 v61, v14, v86, v61
  v_dot2_f32_bf16 v61, v15, v87, v61
  s_waitcnt vmcnt(4)
  buffer_load_dwordx4 v[36:39], v1, s[20:23], s55 offen offset:768 nt
  v_dot2_f32_bf16 v62, v16, v84, 0
  v_dot2_f32_bf16 v62, v17, v85, v62
  v_dot2_f32_bf16 v62, v18, v86, v62
  v_dot2_f32_bf16 v62, v19, v87, v62
  s_add_u32 s68, s69, 8585216
  s_waitcnt vmcnt(4)
  v_dot2_f32_bf16 v63, v20, v84, 0
  v_dot2_f32_bf16 v63, v21, v85, v63
  v_dot2_f32_bf16 v63, v22, v86, v63
  v_dot2_f32_bf16 v63, v23, v87, v63
  s_waitcnt vmcnt(3)
  buffer_load_dwordx4 v[40:43], v1, s[20:23], s55 offen offset:1024 nt
  buffer_load_dwordx4 v[44:47], v1, s[20:23], s55 offen offset:1280 nt
  v_cvt_pk_bf16_f32 v64, v56, v57
  v_cvt_pk_bf16_f32 v65, v58, v59
  v_cvt_pk_bf16_f32 v66, v60, v61
  v_cvt_pk_bf16_f32 v67, v62, v63
  v_dot2_f32_bf16 v56, v24, v116, 0
  v_dot2_f32_bf16 v56, v25, v117, v56
  v_dot2_f32_bf16 v56, v26, v118, v56
  v_dot2_f32_bf16 v56, v27, v119, v56
  v_mfma_f32_16x16x32_bf16 v[68:71], v[64:67], a[16:19], v[68:71]
  v_mfma_f32_16x16x32_bf16 v[72:75], v[64:67], a[20:23], v[72:75]
  v_mfma_f32_16x16x32_bf16 v[76:79], v[64:67], a[24:27], v[76:79]
  v_mfma_f32_16x16x32_bf16 v[80:83], v[64:67], a[28:31], v[80:83]
  s_waitcnt vmcnt(4)
  buffer_load_dwordx4 v[48:51], v1, s[20:23], s55 offen offset:1536 nt
  v_dot2_f32_bf16 v57, v28, v116, 0
  v_dot2_f32_bf16 v57, v29, v117, v57
  v_dot2_f32_bf16 v57, v30, v118, v57
  v_dot2_f32_bf16 v57, v31, v119, v57
  s_waitcnt vmcnt(4)
  buffer_load_dwordx4 v[52:55], v1, s[20:23], s55 offen offset:1792 nt
  v_dot2_f32_bf16 v58, v32, v116, 0
  v_dot2_f32_bf16 v58, v33, v117, v58
  v_dot2_f32_bf16 v58, v34, v118, v58
  v_dot2_f32_bf16 v58, v35, v119, v58
  s_waitcnt vmcnt(4)
  v_dot2_f32_bf16 v59, v36, v116, 0
  v_dot2_f32_bf16 v59, v37, v117, v59
  v_dot2_f32_bf16 v59, v38, v118, v59
  v_dot2_f32_bf16 v59, v39, v119, v59
  s_waitcnt vmcnt(3)
  buffer_load_dwordx4 v[8:11], v1, s[20:23], s68 offen offset:0 nt
  buffer_load_dwordx4 v[12:15], v1, s[20:23], s68 offen offset:256 nt
  v_dot2_f32_bf16 v60, v40, v116, 0
  v_dot2_f32_bf16 v60, v41, v117, v60
  v_dot2_f32_bf16 v60, v42, v118, v60
  v_dot2_f32_bf16 v60, v43, v119, v60
  s_waitcnt vmcnt(4)
  buffer_load_dwordx4 v[16:19], v1, s[20:23], s68 offen offset:512 nt
  v_dot2_f32_bf16 v61, v44, v116, 0
  v_dot2_f32_bf16 v61, v45, v117, v61
  v_dot2_f32_bf16 v61, v46, v118, v61
  v_dot2_f32_bf16 v61, v47, v119, v61
  s_waitcnt vmcnt(4)
  buffer_load_dwordx4 v[20:23], v1, s[20:23], s68 offen offset:768 nt
  v_dot2_f32_bf16 v62, v48, v116, 0
  v_dot2_f32_bf16 v62, v49, v117, v62
  v_dot2_f32_bf16 v62, v50, v118, v62
  v_dot2_f32_bf16 v62, v51, v119, v62
  s_add_u32 s55, s69, 12713984
  s_waitcnt vmcnt(4)
  v_dot2_f32_bf16 v63, v52, v116, 0
  v_dot2_f32_bf16 v63, v53, v117, v63
  v_dot2_f32_bf16 v63, v54, v118, v63
  v_dot2_f32_bf16 v63, v55, v119, v63
  s_waitcnt vmcnt(3)
  buffer_load_dwordx4 v[24:27], v1, s[20:23], s68 offen offset:1024 nt
  buffer_load_dwordx4 v[28:31], v1, s[20:23], s68 offen offset:1280 nt
  v_cvt_pk_bf16_f32 v88, v56, v57
  v_cvt_pk_bf16_f32 v89, v58, v59
  v_cvt_pk_bf16_f32 v90, v60, v61
  v_cvt_pk_bf16_f32 v91, v62, v63
  v_dot2_f32_bf16 v56, v8, v116, 0
  v_dot2_f32_bf16 v56, v9, v117, v56
  v_dot2_f32_bf16 v56, v10, v118, v56
  v_dot2_f32_bf16 v56, v11, v119, v56
  v_mfma_f32_16x16x32_bf16 v[92:95], v[88:91], a[32:35], v[92:95]
  v_mfma_f32_16x16x32_bf16 v[96:99], v[88:91], a[36:39], v[96:99]
  v_mfma_f32_16x16x32_bf16 v[100:103], v[88:91], a[40:43], v[100:103]
  v_mfma_f32_16x16x32_bf16 v[104:107], v[88:91], a[44:47], v[104:107]
  s_waitcnt vmcnt(4)
  buffer_load_dwordx4 v[32:35], v1, s[20:23], s68 offen offset:1536 nt
  v_dot2_f32_bf16 v57, v12, v116, 0
  v_dot2_f32_bf16 v57, v13, v117, v57
  v_dot2_f32_bf16 v57, v14, v118, v57
  v_dot2_f32_bf16 v57, v15, v119, v57
  s_waitcnt vmcnt(4)
  buffer_load_dwordx4 v[36:39], v1, s[20:23], s68 offen offset:1792 nt
  v_dot2_f32_bf16 v58, v16, v116, 0
  v_dot2_f32_bf16 v58, v17, v117, v58
  v_dot2_f32_bf16 v58, v18, v118, v58
  v_dot2_f32_bf16 v58, v19, v119, v58
  s_waitcnt vmcnt(4)
  v_dot2_f32_bf16 v59, v20, v116, 0
  v_dot2_f32_bf16 v59, v21, v117, v59
  v_dot2_f32_bf16 v59, v22, v118, v59
  v_dot2_f32_bf16 v59, v23, v119, v59
  s_waitcnt vmcnt(3)
  buffer_load_dwordx4 v[40:43], v1, s[20:23], s55 offen offset:0 nt
  buffer_load_dwordx4 v[44:47], v1, s[20:23], s55 offen offset:256 nt
  v_dot2_f32_bf16 v60, v24, v116, 0
  v_dot2_f32_bf16 v60, v25, v117, v60
  v_dot2_f32_bf16 v60, v26, v118, v60
  v_dot2_f32_bf16 v60, v27, v119, v60
  s_waitcnt vmcnt(4)
  buffer_load_dwordx4 v[48:51], v1, s[20:23], s55 offen offset:512 nt
  v_dot2_f32_bf16 v61, v28, v116, 0
  v_dot2_f32_bf16 v61, v29, v117, v61
  v_dot2_f32_bf16 v61, v30, v118, v61
  v_dot2_f32_bf16 v61, v31, v119, v61
  s_waitcnt vmcnt(4)
  buffer_load_dwordx4 v[52:55], v1, s[20:23], s55 offen offset:768 nt
  v_dot2_f32_bf16 v62, v32, v116, 0
  v_dot2_f32_bf16 v62, v33, v117, v62
  v_dot2_f32_bf16 v62, v34, v118, v62
  v_dot2_f32_bf16 v62, v35, v119, v62
  s_add_u32 s68, s69, 12779520
  s_waitcnt vmcnt(4)
  v_dot2_f32_bf16 v63, v36, v116, 0
  v_dot2_f32_bf16 v63, v37, v117, v63
  v_dot2_f32_bf16 v63, v38, v118, v63
  v_dot2_f32_bf16 v63, v39, v119, v63
  s_waitcnt vmcnt(3)
  buffer_load_dwordx4 v[8:11], v1, s[20:23], s55 offen offset:1024 nt
  buffer_load_dwordx4 v[12:15], v1, s[20:23], s55 offen offset:1280 nt
  v_cvt_pk_bf16_f32 v64, v56, v57
  v_cvt_pk_bf16_f32 v65, v58, v59
  v_cvt_pk_bf16_f32 v66, v60, v61
  v_cvt_pk_bf16_f32 v67, v62, v63
  v_dot2_f32_bf16 v56, v40, v84, 0
  v_dot2_f32_bf16 v56, v41, v85, v56
  v_dot2_f32_bf16 v56, v42, v86, v56
  v_dot2_f32_bf16 v56, v43, v87, v56
  v_mfma_f32_16x16x32_bf16 v[92:95], v[64:67], a[48:51], v[92:95]
  v_mfma_f32_16x16x32_bf16 v[96:99], v[64:67], a[52:55], v[96:99]
  v_mfma_f32_16x16x32_bf16 v[100:103], v[64:67], a[56:59], v[100:103]
  v_mfma_f32_16x16x32_bf16 v[104:107], v[64:67], a[60:63], v[104:107]
  s_waitcnt vmcnt(4)
  buffer_load_dwordx4 v[16:19], v1, s[20:23], s55 offen offset:1536 nt
  v_dot2_f32_bf16 v57, v44, v84, 0
  v_dot2_f32_bf16 v57, v45, v85, v57
  v_dot2_f32_bf16 v57, v46, v86, v57
  v_dot2_f32_bf16 v57, v47, v87, v57
  s_waitcnt vmcnt(4)
  buffer_load_dwordx4 v[20:23], v1, s[20:23], s55 offen offset:1792 nt
  v_dot2_f32_bf16 v58, v48, v84, 0
  v_dot2_f32_bf16 v58, v49, v85, v58
  v_dot2_f32_bf16 v58, v50, v86, v58
  v_dot2_f32_bf16 v58, v51, v87, v58
  s_waitcnt vmcnt(4)
  v_dot2_f32_bf16 v59, v52, v84, 0
  v_dot2_f32_bf16 v59, v53, v85, v59
  v_dot2_f32_bf16 v59, v54, v86, v59
  v_dot2_f32_bf16 v59, v55, v87, v59
  s_waitcnt vmcnt(3)
  buffer_load_dwordx4 v[24:27], v1, s[20:23], s68 offen offset:0 nt
  buffer_load_dwordx4 v[28:31], v1, s[20:23], s68 offen offset:256 nt
  v_dot2_f32_bf16 v60, v8, v84, 0
  v_dot2_f32_bf16 v60, v9, v85, v60
  v_dot2_f32_bf16 v60, v10, v86, v60
  v_dot2_f32_bf16 v60, v11, v87, v60
  s_waitcnt vmcnt(4)
  buffer_load_dwordx4 v[32:35], v1, s[20:23], s68 offen offset:512 nt
  v_dot2_f32_bf16 v61, v12, v84, 0
  v_dot2_f32_bf16 v61, v13, v85, v61
  v_dot2_f32_bf16 v61, v14, v86, v61
  v_dot2_f32_bf16 v61, v15, v87, v61
  s_waitcnt vmcnt(4)
  buffer_load_dwordx4 v[36:39], v1, s[20:23], s68 offen offset:768 nt
  v_dot2_f32_bf16 v62, v16, v84, 0
  v_dot2_f32_bf16 v62, v17, v85, v62
  v_dot2_f32_bf16 v62, v18, v86, v62
  v_dot2_f32_bf16 v62, v19, v87, v62
  s_add_u32 s55, s69, 8650752
  s_waitcnt vmcnt(4)
  v_dot2_f32_bf16 v63, v20, v84, 0
  v_dot2_f32_bf16 v63, v21, v85, v63
  v_dot2_f32_bf16 v63, v22, v86, v63
  v_dot2_f32_bf16 v63, v23, v87, v63
  s_waitcnt vmcnt(3)
  buffer_load_dwordx4 v[40:43], v1, s[20:23], s68 offen offset:1024 nt
  buffer_load_dwordx4 v[44:47], v1, s[20:23], s68 offen offset:1280 nt
  v_cvt_pk_bf16_f32 v88, v56, v57
  v_cvt_pk_bf16_f32 v89, v58, v59
  v_cvt_pk_bf16_f32 v90, v60, v61
  v_cvt_pk_bf16_f32 v91, v62, v63
  v_dot2_f32_bf16 v56, v24, v84, 0
  v_dot2_f32_bf16 v56, v25, v85, v56
  v_dot2_f32_bf16 v56, v26, v86, v56
  v_dot2_f32_bf16 v56, v27, v87, v56
  v_mfma_f32_16x16x32_bf16 v[68:71], v[88:91], a[32:35], v[68:71]
  v_mfma_f32_16x16x32_bf16 v[72:75], v[88:91], a[36:39], v[72:75]
  v_mfma_f32_16x16x32_bf16 v[76:79], v[88:91], a[40:43], v[76:79]
  v_mfma_f32_16x16x32_bf16 v[80:83], v[88:91], a[44:47], v[80:83]
  s_waitcnt vmcnt(4)
  buffer_load_dwordx4 v[48:51], v1, s[20:23], s68 offen offset:1536 nt
  v_dot2_f32_bf16 v57, v28, v84, 0
  v_dot2_f32_bf16 v57, v29, v85, v57
  v_dot2_f32_bf16 v57, v30, v86, v57
  v_dot2_f32_bf16 v57, v31, v87, v57
  s_waitcnt vmcnt(4)
  buffer_load_dwordx4 v[52:55], v1, s[20:23], s68 offen offset:1792 nt
  v_dot2_f32_bf16 v58, v32, v84, 0
  v_dot2_f32_bf16 v58, v33, v85, v58
  v_dot2_f32_bf16 v58, v34, v86, v58
  v_dot2_f32_bf16 v58, v35, v87, v58
  s_waitcnt vmcnt(4)
  v_dot2_f32_bf16 v59, v36, v84, 0
  v_dot2_f32_bf16 v59, v37, v85, v59
  v_dot2_f32_bf16 v59, v38, v86, v59
  v_dot2_f32_bf16 v59, v39, v87, v59
  s_waitcnt vmcnt(3)
  buffer_load_dwordx4 v[8:11], v1, s[20:23], s55 offen offset:0 nt
  buffer_load_dwordx4 v[12:15], v1, s[20:23], s55 offen offset:256 nt
  v_dot2_f32_bf16 v60, v40, v84, 0
  v_dot2_f32_bf16 v60, v41, v85, v60
  v_dot2_f32_bf16 v60, v42, v86, v60
  v_dot2_f32_bf16 v60, v43, v87, v60
  s_waitcnt vmcnt(4)
  buffer_load_dwordx4 v[16:19], v1, s[20:23], s55 offen offset:512 nt
  v_dot2_f32_bf16 v61, v44, v84, 0
  v_dot2_f32_bf16 v61, v45, v85, v61
  v_dot2_f32_bf16 v61, v46, v86, v61
  v_dot2_f32_bf16 v61, v47, v87, v61
  s_waitcnt vmcnt(4)
  buffer_load_dwordx4 v[20:23], v1, s[20:23], s55 offen offset:768 nt
  v_dot2_f32_bf16 v62, v48, v84, 0
  v_dot2_f32_bf16 v62, v49, v85, v62
  v_dot2_f32_bf16 v62, v50, v86, v62
  v_dot2_f32_bf16 v62, v51, v87, v62
  s_add_u32 s68, s69, 8716288
  s_waitcnt vmcnt(4)
  v_dot2_f32_bf16 v63, v52, v84, 0
  v_dot2_f32_bf16 v63, v53, v85, v63
  v_dot2_f32_bf16 v63, v54, v86, v63
  v_dot2_f32_bf16 v63, v55, v87, v63
  s_waitcnt vmcnt(3)
  buffer_load_dwordx4 v[24:27], v1, s[20:23], s55 offen offset:1024 nt
  buffer_load_dwordx4 v[28:31], v1, s[20:23], s55 offen offset:1280 nt
  v_cvt_pk_bf16_f32 v64, v56, v57
  v_cvt_pk_bf16_f32 v65, v58, v59
  v_cvt_pk_bf16_f32 v66, v60, v61
  v_cvt_pk_bf16_f32 v67, v62, v63
  v_dot2_f32_bf16 v56, v8, v116, 0
  v_dot2_f32_bf16 v56, v9, v117, v56
  v_dot2_f32_bf16 v56, v10, v118, v56
  v_dot2_f32_bf16 v56, v11, v119, v56
  v_mfma_f32_16x16x32_bf16 v[68:71], v[64:67], a[48:51], v[68:71]
  v_mfma_f32_16x16x32_bf16 v[72:75], v[64:67], a[52:55], v[72:75]
  v_mfma_f32_16x16x32_bf16 v[76:79], v[64:67], a[56:59], v[76:79]
  v_mfma_f32_16x16x32_bf16 v[80:83], v[64:67], a[60:63], v[80:83]
  s_waitcnt vmcnt(4)
  buffer_load_dwordx4 v[32:35], v1, s[20:23], s55 offen offset:1536 nt
  v_dot2_f32_bf16 v57, v12, v116, 0
  v_dot2_f32_bf16 v57, v13, v117, v57
  v_dot2_f32_bf16 v57, v14, v118, v57
  v_dot2_f32_bf16 v57, v15, v119, v57
  s_waitcnt vmcnt(4)
  buffer_load_dwordx4 v[36:39], v1, s[20:23], s55 offen offset:1792 nt
  v_dot2_f32_bf16 v58, v16, v116, 0
  v_dot2_f32_bf16 v58, v17, v117, v58
  v_dot2_f32_bf16 v58, v18, v118, v58
  v_dot2_f32_bf16 v58, v19, v119, v58
  s_waitcnt vmcnt(4)
  v_dot2_f32_bf16 v59, v20, v116, 0
  v_dot2_f32_bf16 v59, v21, v117, v59
  v_dot2_f32_bf16 v59, v22, v118, v59
  v_dot2_f32_bf16 v59, v23, v119, v59
  s_waitcnt vmcnt(3)
  buffer_load_dwordx4 v[40:43], v1, s[20:23], s68 offen offset:0 nt
  buffer_load_dwordx4 v[44:47], v1, s[20:23], s68 offen offset:256 nt
  v_dot2_f32_bf16 v60, v24, v116, 0
  v_dot2_f32_bf16 v60, v25, v117, v60
  v_dot2_f32_bf16 v60, v26, v118, v60
  v_dot2_f32_bf16 v60, v27, v119, v60
  s_waitcnt vmcnt(4)
  buffer_load_dwordx4 v[48:51], v1, s[20:23], s68 offen offset:512 nt
  v_dot2_f32_bf16 v61, v28, v116, 0
  v_dot2_f32_bf16 v61, v29, v117, v61
  v_dot2_f32_bf16 v61, v30, v118, v61
  v_dot2_f32_bf16 v61, v31, v119, v61
  s_waitcnt vmcnt(4)
  buffer_load_dwordx4 v[52:55], v1, s[20:23], s68 offen offset:768 nt
  v_dot2_f32_bf16 v62, v32, v116, 0
  v_dot2_f32_bf16 v62, v33, v117, v62
  v_dot2_f32_bf16 v62, v34, v118, v62
  v_dot2_f32_bf16 v62, v35, v119, v62
  s_add_u32 s55, s69, 12845056
  s_waitcnt vmcnt(4)
  v_dot2_f32_bf16 v63, v36, v116, 0
  v_dot2_f32_bf16 v63, v37, v117, v63
  v_dot2_f32_bf16 v63, v38, v118, v63
  v_dot2_f32_bf16 v63, v39, v119, v63
  s_waitcnt vmcnt(3)
  buffer_load_dwordx4 v[8:11], v1, s[20:23], s68 offen offset:1024 nt
  buffer_load_dwordx4 v[12:15], v1, s[20:23], s68 offen offset:1280 nt
  v_cvt_pk_bf16_f32 v88, v56, v57
  v_cvt_pk_bf16_f32 v89, v58, v59
  v_cvt_pk_bf16_f32 v90, v60, v61
  v_cvt_pk_bf16_f32 v91, v62, v63
  v_dot2_f32_bf16 v56, v40, v116, 0
  v_dot2_f32_bf16 v56, v41, v117, v56
  v_dot2_f32_bf16 v56, v42, v118, v56
  v_dot2_f32_bf16 v56, v43, v119, v56
  v_mfma_f32_16x16x32_bf16 v[92:95], v[88:91], a[64:67], v[92:95]
  v_mfma_f32_16x16x32_bf16 v[96:99], v[88:91], a[68:71], v[96:99]
  v_mfma_f32_16x16x32_bf16 v[100:103], v[88:91], a[72:75], v[100:103]
  v_mfma_f32_16x16x32_bf16 v[104:107], v[88:91], a[76:79], v[104:107]
  s_waitcnt vmcnt(4)
  buffer_load_dwordx4 v[16:19], v1, s[20:23], s68 offen offset:1536 nt
  v_dot2_f32_bf16 v57, v44, v116, 0
  v_dot2_f32_bf16 v57, v45, v117, v57
  v_dot2_f32_bf16 v57, v46, v118, v57
  v_dot2_f32_bf16 v57, v47, v119, v57
  s_waitcnt vmcnt(4)
  buffer_load_dwordx4 v[20:23], v1, s[20:23], s68 offen offset:1792 nt
  v_dot2_f32_bf16 v58, v48, v116, 0
  v_dot2_f32_bf16 v58, v49, v117, v58
  v_dot2_f32_bf16 v58, v50, v118, v58
  v_dot2_f32_bf16 v58, v51, v119, v58
  s_waitcnt vmcnt(4)
  v_dot2_f32_bf16 v59, v52, v116, 0
  v_dot2_f32_bf16 v59, v53, v117, v59
  v_dot2_f32_bf16 v59, v54, v118, v59
  v_dot2_f32_bf16 v59, v55, v119, v59
  s_waitcnt vmcnt(3)
  buffer_load_dwordx4 v[24:27], v1, s[20:23], s55 offen offset:0 nt
  buffer_load_dwordx4 v[28:31], v1, s[20:23], s55 offen offset:256 nt
  v_dot2_f32_bf16 v60, v8, v116, 0
  v_dot2_f32_bf16 v60, v9, v117, v60
  v_dot2_f32_bf16 v60, v10, v118, v60
  v_dot2_f32_bf16 v60, v11, v119, v60
  s_waitcnt vmcnt(4)
  buffer_load_dwordx4 v[32:35], v1, s[20:23], s55 offen offset:512 nt
  v_dot2_f32_bf16 v61, v12, v116, 0
  v_dot2_f32_bf16 v61, v13, v117, v61
  v_dot2_f32_bf16 v61, v14, v118, v61
  v_dot2_f32_bf16 v61, v15, v119, v61
  s_waitcnt vmcnt(4)
  buffer_load_dwordx4 v[36:39], v1, s[20:23], s55 offen offset:768 nt
  v_dot2_f32_bf16 v62, v16, v116, 0
  v_dot2_f32_bf16 v62, v17, v117, v62
  v_dot2_f32_bf16 v62, v18, v118, v62
  v_dot2_f32_bf16 v62, v19, v119, v62
  s_add_u32 s68, s69, 12910592
  s_waitcnt vmcnt(4)
  v_dot2_f32_bf16 v63, v20, v116, 0
  v_dot2_f32_bf16 v63, v21, v117, v63
  v_dot2_f32_bf16 v63, v22, v118, v63
  v_dot2_f32_bf16 v63, v23, v119, v63
  s_waitcnt vmcnt(3)
  buffer_load_dwordx4 v[40:43], v1, s[20:23], s55 offen offset:1024 nt
  buffer_load_dwordx4 v[44:47], v1, s[20:23], s55 offen offset:1280 nt
  v_cvt_pk_bf16_f32 v64, v56, v57
  v_cvt_pk_bf16_f32 v65, v58, v59
  v_cvt_pk_bf16_f32 v66, v60, v61
  v_cvt_pk_bf16_f32 v67, v62, v63
  v_dot2_f32_bf16 v56, v24, v84, 0
  v_dot2_f32_bf16 v56, v25, v85, v56
  v_dot2_f32_bf16 v56, v26, v86, v56
  v_dot2_f32_bf16 v56, v27, v87, v56
  v_mfma_f32_16x16x32_bf16 v[92:95], v[64:67], a[80:83], v[92:95]
  v_mfma_f32_16x16x32_bf16 v[96:99], v[64:67], a[84:87], v[96:99]
  v_mfma_f32_16x16x32_bf16 v[100:103], v[64:67], a[88:91], v[100:103]
  v_mfma_f32_16x16x32_bf16 v[104:107], v[64:67], a[92:95], v[104:107]
  s_waitcnt vmcnt(4)
  buffer_load_dwordx4 v[48:51], v1, s[20:23], s55 offen offset:1536 nt
  v_dot2_f32_bf16 v57, v28, v84, 0
  v_dot2_f32_bf16 v57, v29, v85, v57
  v_dot2_f32_bf16 v57, v30, v86, v57
  v_dot2_f32_bf16 v57, v31, v87, v57
  s_waitcnt vmcnt(4)
  buffer_load_dwordx4 v[52:55], v1, s[20:23], s55 offen offset:1792 nt
  v_dot2_f32_bf16 v58, v32, v84, 0
  v_dot2_f32_bf16 v58, v33, v85, v58
  v_dot2_f32_bf16 v58, v34, v86, v58
  v_dot2_f32_bf16 v58, v35, v87, v58
  s_waitcnt vmcnt(4)
  v_dot2_f32_bf16 v59, v36, v84, 0
  v_dot2_f32_bf16 v59, v37, v85, v59
  v_dot2_f32_bf16 v59, v38, v86, v59
  v_dot2_f32_bf16 v59, v39, v87, v59
  s_waitcnt vmcnt(3)
  buffer_load_dwordx4 v[8:11], v1, s[20:23], s68 offen offset:0 nt
  buffer_load_dwordx4 v[12:15], v1, s[20:23], s68 offen offset:256 nt
  v_dot2_f32_bf16 v60, v40, v84, 0
  v_dot2_f32_bf16 v60, v41, v85, v60
  v_dot2_f32_bf16 v60, v42, v86, v60
  v_dot2_f32_bf16 v60, v43, v87, v60
  s_waitcnt vmcnt(4)
  buffer_load_dwordx4 v[16:19], v1, s[20:23], s68 offen offset:512 nt
  v_dot2_f32_bf16 v61, v44, v84, 0
  v_dot2_f32_bf16 v61, v45, v85, v61
  v_dot2_f32_bf16 v61, v46, v86, v61
  v_dot2_f32_bf16 v61, v47, v87, v61
  s_waitcnt vmcnt(4)
  buffer_load_dwordx4 v[20:23], v1, s[20:23], s68 offen offset:768 nt
  v_dot2_f32_bf16 v62, v48, v84, 0
  v_dot2_f32_bf16 v62, v49, v85, v62
  v_dot2_f32_bf16 v62, v50, v86, v62
  v_dot2_f32_bf16 v62, v51, v87, v62
  s_add_u32 s55, s69, 8781824
  s_waitcnt vmcnt(4)
  v_dot2_f32_bf16 v63, v52, v84, 0
  v_dot2_f32_bf16 v63, v53, v85, v63
  v_dot2_f32_bf16 v63, v54, v86, v63
  v_dot2_f32_bf16 v63, v55, v87, v63
  s_waitcnt vmcnt(3)
  buffer_load_dwordx4 v[24:27], v1, s[20:23], s68 offen offset:1024 nt
  buffer_load_dwordx4 v[28:31], v1, s[20:23], s68 offen offset:1280 nt
  v_cvt_pk_bf16_f32 v88, v56, v57
  v_cvt_pk_bf16_f32 v89, v58, v59
  v_cvt_pk_bf16_f32 v90, v60, v61
  v_cvt_pk_bf16_f32 v91, v62, v63
  v_dot2_f32_bf16 v56, v8, v84, 0
  v_dot2_f32_bf16 v56, v9, v85, v56
  v_dot2_f32_bf16 v56, v10, v86, v56
  v_dot2_f32_bf16 v56, v11, v87, v56
  v_mfma_f32_16x16x32_bf16 v[68:71], v[88:91], a[64:67], v[68:71]
  v_mfma_f32_16x16x32_bf16 v[72:75], v[88:91], a[68:71], v[72:75]
  v_mfma_f32_16x16x32_bf16 v[76:79], v[88:91], a[72:75], v[76:79]
  v_mfma_f32_16x16x32_bf16 v[80:83], v[88:91], a[76:79], v[80:83]
  s_waitcnt vmcnt(4)
  buffer_load_dwordx4 v[32:35], v1, s[20:23], s68 offen offset:1536 nt
  v_dot2_f32_bf16 v57, v12, v84, 0
  v_dot2_f32_bf16 v57, v13, v85, v57
  v_dot2_f32_bf16 v57, v14, v86, v57
  v_dot2_f32_bf16 v57, v15, v87, v57
  s_waitcnt vmcnt(4)
  buffer_load_dwordx4 v[36:39], v1, s[20:23], s68 offen offset:1792 nt
  v_dot2_f32_bf16 v58, v16, v84, 0
  v_dot2_f32_bf16 v58, v17, v85, v58
  v_dot2_f32_bf16 v58, v18, v86, v58
  v_dot2_f32_bf16 v58, v19, v87, v58
  s_waitcnt vmcnt(4)
  v_dot2_f32_bf16 v59, v20, v84, 0
  v_dot2_f32_bf16 v59, v21, v85, v59
  v_dot2_f32_bf16 v59, v22, v86, v59
  v_dot2_f32_bf16 v59, v23, v87, v59
  s_waitcnt vmcnt(3)
  buffer_load_dwordx4 v[40:43], v1, s[20:23], s55 offen offset:0 nt
  buffer_load_dwordx4 v[44:47], v1, s[20:23], s55 offen offset:256 nt
  v_dot2_f32_bf16 v60, v24, v84, 0
  v_dot2_f32_bf16 v60, v25, v85, v60
  v_dot2_f32_bf16 v60, v26, v86, v60
  v_dot2_f32_bf16 v60, v27, v87, v60
  s_waitcnt vmcnt(4)
  buffer_load_dwordx4 v[48:51], v1, s[20:23], s55 offen offset:512 nt
  v_dot2_f32_bf16 v61, v28, v84, 0
  v_dot2_f32_bf16 v61, v29, v85, v61
  v_dot2_f32_bf16 v61, v30, v86, v61
  v_dot2_f32_bf16 v61, v31, v87, v61
  s_waitcnt vmcnt(4)
  buffer_load_dwordx4 v[52:55], v1, s[20:23], s55 offen offset:768 nt
  v_dot2_f32_bf16 v62, v32, v84, 0
  v_dot2_f32_bf16 v62, v33, v85, v62
  v_dot2_f32_bf16 v62, v34, v86, v62
  v_dot2_f32_bf16 v62, v35, v87, v62
  s_add_u32 s68, s69, 8847360
  s_waitcnt vmcnt(4)
  v_dot2_f32_bf16 v63, v36, v84, 0
  v_dot2_f32_bf16 v63, v37, v85, v63
  v_dot2_f32_bf16 v63, v38, v86, v63
  v_dot2_f32_bf16 v63, v39, v87, v63
  s_waitcnt vmcnt(3)
  buffer_load_dwordx4 v[8:11], v1, s[20:23], s55 offen offset:1024 nt
  buffer_load_dwordx4 v[12:15], v1, s[20:23], s55 offen offset:1280 nt
  v_cvt_pk_bf16_f32 v64, v56, v57
  v_cvt_pk_bf16_f32 v65, v58, v59
  v_cvt_pk_bf16_f32 v66, v60, v61
  v_cvt_pk_bf16_f32 v67, v62, v63
  v_dot2_f32_bf16 v56, v40, v116, 0
  v_dot2_f32_bf16 v56, v41, v117, v56
  v_dot2_f32_bf16 v56, v42, v118, v56
  v_dot2_f32_bf16 v56, v43, v119, v56
  v_mfma_f32_16x16x32_bf16 v[68:71], v[64:67], a[80:83], v[68:71]
  v_mfma_f32_16x16x32_bf16 v[72:75], v[64:67], a[84:87], v[72:75]
  v_mfma_f32_16x16x32_bf16 v[76:79], v[64:67], a[88:91], v[76:79]
  v_mfma_f32_16x16x32_bf16 v[80:83], v[64:67], a[92:95], v[80:83]
  s_waitcnt vmcnt(4)
  buffer_load_dwordx4 v[16:19], v1, s[20:23], s55 offen offset:1536 nt
  v_dot2_f32_bf16 v57, v44, v116, 0
  v_dot2_f32_bf16 v57, v45, v117, v57
  v_dot2_f32_bf16 v57, v46, v118, v57
  v_dot2_f32_bf16 v57, v47, v119, v57
  s_waitcnt vmcnt(4)
  buffer_load_dwordx4 v[20:23], v1, s[20:23], s55 offen offset:1792 nt
  v_dot2_f32_bf16 v58, v48, v116, 0
  v_dot2_f32_bf16 v58, v49, v117, v58
  v_dot2_f32_bf16 v58, v50, v118, v58
  v_dot2_f32_bf16 v58, v51, v119, v58
  s_waitcnt vmcnt(4)
  v_dot2_f32_bf16 v59, v52, v116, 0
  v_dot2_f32_bf16 v59, v53, v117, v59
  v_dot2_f32_bf16 v59, v54, v118, v59
  v_dot2_f32_bf16 v59, v55, v119, v59
  s_waitcnt vmcnt(3)
  buffer_load_dwordx4 v[24:27], v1, s[20:23], s68 offen offset:0 nt
  buffer_load_dwordx4 v[28:31], v1, s[20:23], s68 offen offset:256 nt
  v_dot2_f32_bf16 v60, v8, v116, 0
  v_dot2_f32_bf16 v60, v9, v117, v60
  v_dot2_f32_bf16 v60, v10, v118, v60
  v_dot2_f32_bf16 v60, v11, v119, v60
  s_waitcnt vmcnt(4)
  buffer_load_dwordx4 v[32:35], v1, s[20:23], s68 offen offset:512 nt
  v_dot2_f32_bf16 v61, v12, v116, 0
  v_dot2_f32_bf16 v61, v13, v117, v61
  v_dot2_f32_bf16 v61, v14, v118, v61
  v_dot2_f32_bf16 v61, v15, v119, v61
  s_waitcnt vmcnt(4)
  buffer_load_dwordx4 v[36:39], v1, s[20:23], s68 offen offset:768 nt
  v_dot2_f32_bf16 v62, v16, v116, 0
  v_dot2_f32_bf16 v62, v17, v117, v62
  v_dot2_f32_bf16 v62, v18, v118, v62
  v_dot2_f32_bf16 v62, v19, v119, v62
  s_add_u32 s55, s69, 12976128
  s_waitcnt vmcnt(4)
  v_dot2_f32_bf16 v63, v20, v116, 0
  v_dot2_f32_bf16 v63, v21, v117, v63
  v_dot2_f32_bf16 v63, v22, v118, v63
  v_dot2_f32_bf16 v63, v23, v119, v63
  s_waitcnt vmcnt(3)
  buffer_load_dwordx4 v[40:43], v1, s[20:23], s68 offen offset:1024 nt
  buffer_load_dwordx4 v[44:47], v1, s[20:23], s68 offen offset:1280 nt
  v_cvt_pk_bf16_f32 v88, v56, v57
  v_cvt_pk_bf16_f32 v89, v58, v59
  v_cvt_pk_bf16_f32 v90, v60, v61
  v_cvt_pk_bf16_f32 v91, v62, v63
  v_dot2_f32_bf16 v56, v24, v116, 0
  v_dot2_f32_bf16 v56, v25, v117, v56
  v_dot2_f32_bf16 v56, v26, v118, v56
  v_dot2_f32_bf16 v56, v27, v119, v56
  v_mfma_f32_16x16x32_bf16 v[92:95], v[88:91], a[96:99], v[92:95]
  v_mfma_f32_16x16x32_bf16 v[96:99], v[88:91], a[100:103], v[96:99]
  v_mfma_f32_16x16x32_bf16 v[100:103], v[88:91], a[104:107], v[100:103]
  v_mfma_f32_16x16x32_bf16 v[104:107], v[88:91], a[108:111], v[104:107]
  s_waitcnt vmcnt(4)
  buffer_load_dwordx4 v[48:51], v1, s[20:23], s68 offen offset:1536 nt
  v_dot2_f32_bf16 v57, v28, v116, 0
  v_dot2_f32_bf16 v57, v29, v117, v57
  v_dot2_f32_bf16 v57, v30, v118, v57
  v_dot2_f32_bf16 v57, v31, v119, v57
  s_waitcnt vmcnt(4)
  buffer_load_dwordx4 v[52:55], v1, s[20:23], s68 offen offset:1792 nt
  v_dot2_f32_bf16 v58, v32, v116, 0
  v_dot2_f32_bf16 v58, v33, v117, v58
  v_dot2_f32_bf16 v58, v34, v118, v58
  v_dot2_f32_bf16 v58, v35, v119, v58
  s_waitcnt vmcnt(4)
  v_dot2_f32_bf16 v59, v36, v116, 0
  v_dot2_f32_bf16 v59, v37, v117, v59
  v_dot2_f32_bf16 v59, v38, v118, v59
  v_dot2_f32_bf16 v59, v39, v119, v59
  s_waitcnt vmcnt(3)
  buffer_load_dwordx4 v[8:11], v1, s[20:23], s55 offen offset:0 nt
  buffer_load_dwordx4 v[12:15], v1, s[20:23], s55 offen offset:256 nt
  v_dot2_f32_bf16 v60, v40, v116, 0
  v_dot2_f32_bf16 v60, v41, v117, v60
  v_dot2_f32_bf16 v60, v42, v118, v60
  v_dot2_f32_bf16 v60, v43, v119, v60
  s_waitcnt vmcnt(4)
  buffer_load_dwordx4 v[16:19], v1, s[20:23], s55 offen offset:512 nt
  v_dot2_f32_bf16 v61, v44, v116, 0
  v_dot2_f32_bf16 v61, v45, v117, v61
  v_dot2_f32_bf16 v61, v46, v118, v61
  v_dot2_f32_bf16 v61, v47, v119, v61
  s_waitcnt vmcnt(4)
  buffer_load_dwordx4 v[20:23], v1, s[20:23], s55 offen offset:768 nt
  v_dot2_f32_bf16 v62, v48, v116, 0
  v_dot2_f32_bf16 v62, v49, v117, v62
  v_dot2_f32_bf16 v62, v50, v118, v62
  v_dot2_f32_bf16 v62, v51, v119, v62
  s_add_u32 s68, s69, 13041664
  s_waitcnt vmcnt(4)
  v_dot2_f32_bf16 v63, v52, v116, 0
  v_dot2_f32_bf16 v63, v53, v117, v63
  v_dot2_f32_bf16 v63, v54, v118, v63
  v_dot2_f32_bf16 v63, v55, v119, v63
  s_waitcnt vmcnt(3)
  buffer_load_dwordx4 v[24:27], v1, s[20:23], s55 offen offset:1024 nt
  buffer_load_dwordx4 v[28:31], v1, s[20:23], s55 offen offset:1280 nt
  v_cvt_pk_bf16_f32 v64, v56, v57
  v_cvt_pk_bf16_f32 v65, v58, v59
  v_cvt_pk_bf16_f32 v66, v60, v61
  v_cvt_pk_bf16_f32 v67, v62, v63
  v_dot2_f32_bf16 v56, v8, v84, 0
  v_dot2_f32_bf16 v56, v9, v85, v56
  v_dot2_f32_bf16 v56, v10, v86, v56
  v_dot2_f32_bf16 v56, v11, v87, v56
  v_mfma_f32_16x16x32_bf16 v[92:95], v[64:67], a[112:115], v[92:95]
  v_mfma_f32_16x16x32_bf16 v[96:99], v[64:67], a[116:119], v[96:99]
  v_mfma_f32_16x16x32_bf16 v[100:103], v[64:67], a[120:123], v[100:103]
  v_mfma_f32_16x16x32_bf16 v[104:107], v[64:67], a[124:127], v[104:107]
  s_waitcnt vmcnt(4)
  buffer_load_dwordx4 v[32:35], v1, s[20:23], s55 offen offset:1536 nt
  v_dot2_f32_bf16 v57, v12, v84, 0
  v_dot2_f32_bf16 v57, v13, v85, v57
  v_dot2_f32_bf16 v57, v14, v86, v57
  v_dot2_f32_bf16 v57, v15, v87, v57
  v_add_f32 v92, v92, v93
  v_add_f32 v96, v96, v97
  v_add_f32 v100, v100, v101
  v_add_f32 v104, v104, v105
  v_add_f32 v94, v94, v95
  v_add_f32 v98, v98, v99
  v_add_f32 v102, v102, v103
  v_add_f32 v106, v106, v107
  v_add_f32 v92, v92, v94
  v_add_f32 v96, v96, v98
  v_add_f32 v100, v100, v102
  v_add_f32 v104, v104, v106
  ds_write_b32 v3, v92 offset:0
  ds_write_b32 v3, v96 offset:1024
  ds_write_b32 v3, v100 offset:2048
  ds_write_b32 v3, v104 offset:3072
  s_waitcnt vmcnt(4)
  buffer_load_dwordx4 v[36:39], v1, s[20:23], s55 offen offset:1792 nt
  v_dot2_f32_bf16 v58, v16, v84, 0
  v_dot2_f32_bf16 v58, v17, v85, v58
  v_dot2_f32_bf16 v58, v18, v86, v58
  v_dot2_f32_bf16 v58, v19, v87, v58
  s_waitcnt vmcnt(4)
  v_dot2_f32_bf16 v59, v20, v84, 0
  v_dot2_f32_bf16 v59, v21, v85, v59
  v_dot2_f32_bf16 v59, v22, v86, v59
  v_dot2_f32_bf16 v59, v23, v87, v59
  s_waitcnt vmcnt(3)
  buffer_load_dwordx4 v[40:43], v1, s[20:23], s68 offen offset:0 nt
  buffer_load_dwordx4 v[44:47], v1, s[20:23], s68 offen offset:256 nt
  v_dot2_f32_bf16 v60, v24, v84, 0
  v_dot2_f32_bf16 v60, v25, v85, v60
  v_dot2_f32_bf16 v60, v26, v86, v60
  v_dot2_f32_bf16 v60, v27, v87, v60
  s_waitcnt vmcnt(4)
  buffer_load_dwordx4 v[48:51], v1, s[20:23], s68 offen offset:512 nt
  v_dot2_f32_bf16 v61, v28, v84, 0
  v_dot2_f32_bf16 v61, v29, v85, v61
  v_dot2_f32_bf16 v61, v30, v86, v61
  v_dot2_f32_bf16 v61, v31, v87, v61
  s_waitcnt vmcnt(4)
  buffer_load_dwordx4 v[52:55], v1, s[20:23], s68 offen offset:768 nt
  s_waitcnt lgkmcnt(0)
  s_barrier
  v_dot2_f32_bf16 v62, v32, v84, 0
  v_dot2_f32_bf16 v62, v33, v85, v62
  v_dot2_f32_bf16 v62, v34, v86, v62
  v_dot2_f32_bf16 v62, v35, v87, v62
  s_mov_b32 s55, s88
  s_waitcnt vmcnt(4)
  v_dot2_f32_bf16 v63, v36, v84, 0
  v_dot2_f32_bf16 v63, v37, v85, v63
  v_dot2_f32_bf16 v63, v38, v86, v63
  v_dot2_f32_bf16 v63, v39, v87, v63
  s_waitcnt vmcnt(3)
  buffer_load_dwordx4 v[8:11], v1, s[20:23], s68 offen offset:1024 nt
  buffer_load_dwordx4 v[12:15], v1, s[20:23], s68 offen offset:1280 nt
  v_cvt_pk_bf16_f32 v88, v56, v57
  v_cvt_pk_bf16_f32 v89, v58, v59
  v_cvt_pk_bf16_f32 v90, v60, v61
  v_cvt_pk_bf16_f32 v91, v62, v63
  v_dot2_f32_bf16 v56, v40, v84, 0
  v_dot2_f32_bf16 v56, v41, v85, v56
  v_dot2_f32_bf16 v56, v42, v86, v56
  v_dot2_f32_bf16 v56, v43, v87, v56
  v_mfma_f32_16x16x32_bf16 v[68:71], v[88:91], a[96:99], v[68:71]
  v_mfma_f32_16x16x32_bf16 v[72:75], v[88:91], a[100:103], v[72:75]
  v_mfma_f32_16x16x32_bf16 v[76:79], v[88:91], a[104:107], v[76:79]
  v_mfma_f32_16x16x32_bf16 v[80:83], v[88:91], a[108:111], v[80:83]
  s_waitcnt vmcnt(4)
  buffer_load_dwordx4 v[16:19], v1, s[20:23], s68 offen offset:1536 nt
  v_dot2_f32_bf16 v57, v44, v84, 0
  v_dot2_f32_bf16 v57, v45, v85, v57
  v_dot2_f32_bf16 v57, v46, v86, v57
  v_dot2_f32_bf16 v57, v47, v87, v57
  s_waitcnt vmcnt(4)
  buffer_load_dwordx4 v[20:23], v1, s[20:23], s68 offen offset:1792 nt
  v_dot2_f32_bf16 v58, v48, v84, 0
  v_dot2_f32_bf16 v58, v49, v85, v58
  v_dot2_f32_bf16 v58, v50, v86, v58
  v_dot2_f32_bf16 v58, v51, v87, v58
  s_waitcnt vmcnt(4)
  v_dot2_f32_bf16 v59, v52, v84, 0
  v_dot2_f32_bf16 v59, v53, v85, v59
  v_dot2_f32_bf16 v59, v54, v86, v59
  v_dot2_f32_bf16 v59, v55, v87, v59
  s_waitcnt vmcnt(3)
  buffer_load_dwordx4 v[24:27], v1, s[24:27], s55 offen offset:0 nt
  buffer_load_dwordx4 v[28:31], v1, s[24:27], s55 offen offset:256 nt
  v_dot2_f32_bf16 v60, v8, v84, 0
  v_dot2_f32_bf16 v60, v9, v85, v60
  v_dot2_f32_bf16 v60, v10, v86, v60
  v_dot2_f32_bf16 v60, v11, v87, v60
  s_waitcnt vmcnt(4)
  buffer_load_dwordx4 v[32:35], v1, s[24:27], s55 offen offset:512 nt
  v_dot2_f32_bf16 v61, v12, v84, 0
  v_dot2_f32_bf16 v61, v13, v85, v61
  v_dot2_f32_bf16 v61, v14, v86, v61
  v_dot2_f32_bf16 v61, v15, v87, v61
  s_waitcnt vmcnt(4)
  buffer_load_dwordx4 v[36:39], v1, s[24:27], s55 offen offset:768 nt
  v_dot2_f32_bf16 v62, v16, v84, 0
  v_dot2_f32_bf16 v62, v17, v85, v62
  v_dot2_f32_bf16 v62, v18, v86, v62
  v_dot2_f32_bf16 v62, v19, v87, v62
  s_add_u32 s68, s88, 65536
  s_waitcnt vmcnt(4)
  v_dot2_f32_bf16 v63, v20, v84, 0
  v_dot2_f32_bf16 v63, v21, v85, v63
  v_dot2_f32_bf16 v63, v22, v86, v63
  v_dot2_f32_bf16 v63, v23, v87, v63
  s_waitcnt vmcnt(3)
  buffer_load_dwordx4 v[40:43], v1, s[24:27], s55 offen offset:1024 nt
  buffer_load_dwordx4 v[44:47], v1, s[24:27], s55 offen offset:1280 nt
  v_cvt_pk_bf16_f32 v64, v56, v57
  v_cvt_pk_bf16_f32 v65, v58, v59
  v_cvt_pk_bf16_f32 v66, v60, v61
  v_cvt_pk_bf16_f32 v67, v62, v63
  s_nop 1
  v_mfma_f32_16x16x32_bf16 v[68:71], v[64:67], a[112:115], v[68:71]
  v_mfma_f32_16x16x32_bf16 v[72:75], v[64:67], a[116:119], v[72:75]
  v_mfma_f32_16x16x32_bf16 v[76:79], v[64:67], a[120:123], v[76:79]
  v_mfma_f32_16x16x32_bf16 v[80:83], v[64:67], a[124:127], v[80:83]
  s_waitcnt vmcnt(4)
  buffer_load_dwordx4 v[48:51], v1, s[24:27], s55 offen offset:1536 nt
  s_nop 2
  v_add_f32 v68, v68, v69
  v_add_f32 v72, v72, v73
  v_add_f32 v76, v76, v77
  v_add_f32 v80, v80, v81
  v_add_f32 v70, v70, v71
  v_add_f32 v74, v74, v75
  v_add_f32 v78, v78, v79
  v_add_f32 v82, v82, v83
  v_add_f32 v68, v68, v70
  v_add_f32 v72, v72, v74
  v_add_f32 v76, v76, v78
  v_add_f32 v80, v80, v82
  ds_write_b32 v3, v68 offset:4096
  ds_write_b32 v3, v72 offset:5120
  ds_write_b32 v3, v76 offset:6144
  ds_write_b32 v3, v80 offset:7168
  v_perm_b32 v88, v28, v24, s58
  v_perm_b32 v92, v28, v24, s59
  v_perm_b32 v96, v29, v25, s58
  v_perm_b32 v100, v29, v25, s59
  v_perm_b32 v104, v30, v26, s58
  v_perm_b32 v108, v30, v26, s59
  v_perm_b32 v112, v31, v27, s58
  v_perm_b32 v116, v31, v27, s59
  s_waitcnt vmcnt(4)
  buffer_load_dwordx4 v[52:55], v1, s[24:27], s55 offen offset:1792 nt
  s_waitcnt lgkmcnt(0)
  s_barrier
  s_waitcnt vmcnt(4)
  v_perm_b32 v89, v36, v32, s58
  v_perm_b32 v93, v36, v32, s59
  v_perm_b32 v97, v37, v33, s58
  v_perm_b32 v101, v37, v33, s59
  v_perm_b32 v105, v38, v34, s58
  v_perm_b32 v109, v38, v34, s59
  v_perm_b32 v113, v39, v35, s58
  v_perm_b32 v117, v39, v35, s59
  ds_read_b128 v[120:123], v5 offset:0
  s_waitcnt vmcnt(3)
  buffer_load_dwordx4 v[8:11], v1, s[24:27], s68 offen offset:0 nt
  buffer_load_dwordx4 v[12:15], v1, s[24:27], s68 offen offset:256 nt
  s_waitcnt vmcnt(4)
  buffer_load_dwordx4 v[16:19], v1, s[24:27], s68 offen offset:512 nt
  v_perm_b32 v90, v44, v40, s58
  v_perm_b32 v94, v44, v40, s59
  v_perm_b32 v98, v45, v41, s58
  v_perm_b32 v102, v45, v41, s59
  v_perm_b32 v106, v46, v42, s58
  v_perm_b32 v110, v46, v42, s59
  v_perm_b32 v114, v47, v43, s58
  v_perm_b32 v118, v47, v43, s59
  s_waitcnt vmcnt(4)
  buffer_load_dwordx4 v[20:23], v1, s[24:27], s68 offen offset:768 nt
  s_add_u32 s55, s88, 131072
  s_waitcnt vmcnt(4)
  v_perm_b32 v91, v52, v48, s58
  v_perm_b32 v95, v52, v48, s59
  v_perm_b32 v99, v53, v49, s58
  v_perm_b32 v103, v53, v49, s59
  v_perm_b32 v107, v54, v50, s58
  v_perm_b32 v111, v54, v50, s59
  v_perm_b32 v115, v55, v51, s58
  v_perm_b32 v119, v55, v51, s59
  s_waitcnt vmcnt(3)
  buffer_load_dwordx4 v[24:27], v1, s[24:27], s68 offen offset:1024 nt
  buffer_load_dwordx4 v[28:31], v1, s[24:27], s68 offen offset:1280 nt
  s_waitcnt lgkmcnt(0)
  v_mfma_f32_16x16x32_bf16 a[0:3], v[120:123], v[88:91], 0
  v_mfma_f32_16x16x32_bf16 a[4:7], v[120:123], v[92:95], 0
  s_waitcnt vmcnt(4)
  buffer_load_dwordx4 v[32:35], v1, s[24:27], s68 offen offset:1536 nt
  v_perm_b32 v56, v12, v8, s58
  v_perm_b32 v60, v12, v8, s59
  v_perm_b32 v64, v13, v9, s58
  v_perm_b32 v68, v13, v9, s59
  v_perm_b32 v72, v14, v10, s58
  v_perm_b32 v76, v14, v10, s59
  v_perm_b32 v80, v15, v11, s58
  v_perm_b32 v84, v15, v11, s59
  s_waitcnt vmcnt(4)
  buffer_load_dwordx4 v[36:39], v1, s[24:27], s68 offen offset:1792 nt
  v_mfma_f32_16x16x32_bf16 a[8:11], v[120:123], v[96:99], 0
  v_mfma_f32_16x16x32_bf16 a[12:15], v[120:123], v[100:103], 0
  s_waitcnt vmcnt(4)
  v_perm_b32 v57, v20, v16, s58
  v_perm_b32 v61, v20, v16, s59
  v_perm_b32 v65, v21, v17, s58
  v_perm_b32 v69, v21, v17, s59
  v_perm_b32 v73, v22, v18, s58
  v_perm_b32 v77, v22, v18, s59
  v_perm_b32 v81, v23, v19, s58
  v_perm_b32 v85, v23, v19, s59
  ds_read_b128 v[124:127], v5 offset:512
  s_waitcnt vmcnt(3)
  buffer_load_dwordx4 v[40:43], v1, s[24:27], s55 offen offset:0 nt
  buffer_load_dwordx4 v[44:47], v1, s[24:27], s55 offen offset:256 nt
  v_mfma_f32_16x16x32_bf16 a[16:19], v[120:123], v[104:107], 0
  v_mfma_f32_16x16x32_bf16 a[20:23], v[120:123], v[108:111], 0
  s_waitcnt vmcnt(4)
  buffer_load_dwordx4 v[48:51], v1, s[24:27], s55 offen offset:512 nt
  v_perm_b32 v58, v28, v24, s58
  v_perm_b32 v62, v28, v24, s59
  v_perm_b32 v66, v29, v25, s58
  v_perm_b32 v70, v29, v25, s59
  v_perm_b32 v74, v30, v26, s58
  v_perm_b32 v78, v30, v26, s59
  v_perm_b32 v82, v31, v27, s58
  v_perm_b32 v86, v31, v27, s59
  s_waitcnt vmcnt(4)
  buffer_load_dwordx4 v[52:55], v1, s[24:27], s55 offen offset:768 nt
  v_mfma_f32_16x16x32_bf16 a[24:27], v[120:123], v[112:115], 0
  v_mfma_f32_16x16x32_bf16 a[28:31], v[120:123], v[116:119], 0
  s_add_u32 s68, s88, 196608
  s_waitcnt vmcnt(4)
  v_perm_b32 v59, v36, v32, s58
  v_perm_b32 v63, v36, v32, s59
  v_perm_b32 v67, v37, v33, s58
  v_perm_b32 v71, v37, v33, s59
  v_perm_b32 v75, v38, v34, s58
  v_perm_b32 v79, v38, v34, s59
  v_perm_b32 v83, v39, v35, s58
  v_perm_b32 v87, v39, v35, s59
  s_waitcnt vmcnt(3)
  buffer_load_dwordx4 v[8:11], v1, s[24:27], s55 offen offset:1024 nt
  buffer_load_dwordx4 v[12:15], v1, s[24:27], s55 offen offset:1280 nt
  s_waitcnt lgkmcnt(0)
  v_mfma_f32_16x16x32_bf16 a[0:3], v[124:127], v[56:59], a[0:3]
  v_mfma_f32_16x16x32_bf16 a[4:7], v[124:127], v[60:63], a[4:7]
  s_waitcnt vmcnt(4)
  buffer_load_dwordx4 v[16:19], v1, s[24:27], s55 offen offset:1536 nt
  v_perm_b32 v88, v44, v40, s58
  v_perm_b32 v92, v44, v40, s59
  v_perm_b32 v96, v45, v41, s58
  v_perm_b32 v100, v45, v41, s59
  v_perm_b32 v104, v46, v42, s58
  v_perm_b32 v108, v46, v42, s59
  v_perm_b32 v112, v47, v43, s58
  v_perm_b32 v116, v47, v43, s59
  s_waitcnt vmcnt(4)
  buffer_load_dwordx4 v[20:23], v1, s[24:27], s55 offen offset:1792 nt
  v_mfma_f32_16x16x32_bf16 a[8:11], v[124:127], v[64:67], a[8:11]
  v_mfma_f32_16x16x32_bf16 a[12:15], v[124:127], v[68:71], a[12:15]
  s_waitcnt vmcnt(4)
  v_perm_b32 v89, v52, v48, s58
  v_perm_b32 v93, v52, v48, s59
  v_perm_b32 v97, v53, v49, s58
  v_perm_b32 v101, v53, v49, s59
  v_perm_b32 v105, v54, v50, s58
  v_perm_b32 v109, v54, v50, s59
  v_perm_b32 v113, v55, v51, s58
  v_perm_b32 v117, v55, v51, s59
  ds_read_b128 v[120:123], v5 offset:1024
  s_waitcnt vmcnt(3)
  buffer_load_dwordx4 v[24:27], v1, s[24:27], s68 offen offset:0 nt
  buffer_load_dwordx4 v[28:31], v1, s[24:27], s68 offen offset:256 nt
  v_mfma_f32_16x16x32_bf16 a[16:19], v[124:127], v[72:75], a[16:19]
  v_mfma_f32_16x16x32_bf16 a[20:23], v[124:127], v[76:79], a[20:23]
  s_waitcnt vmcnt(4)
  buffer_load_dwordx4 v[32:35], v1, s[24:27], s68 offen offset:512 nt
  v_perm_b32 v90, v12, v8, s58
  v_perm_b32 v94, v12, v8, s59
  v_perm_b32 v98, v13, v9, s58
  v_perm_b32 v102, v13, v9, s59
  v_perm_b32 v106, v14, v10, s58
  v_perm_b32 v110, v14, v10, s59
  v_perm_b32 v114, v15, v11, s58
  v_perm_b32 v118, v15, v11, s59
  s_waitcnt vmcnt(4)
  buffer_load_dwordx4 v[36:39], v1, s[24:27], s68 offen offset:768 nt
  v_mfma_f32_16x16x32_bf16 a[24:27], v[124:127], v[80:83], a[24:27]
  v_mfma_f32_16x16x32_bf16 a[28:31], v[124:127], v[84:87], a[28:31]
  s_add_u32 s55, s88, 262144
  s_waitcnt vmcnt(4)
  v_perm_b32 v91, v20, v16, s58
  v_perm_b32 v95, v20, v16, s59
  v_perm_b32 v99, v21, v17, s58
  v_perm_b32 v103, v21, v17, s59
  v_perm_b32 v107, v22, v18, s58
  v_perm_b32 v111, v22, v18, s59
  v_perm_b32 v115, v23, v19, s58
  v_perm_b32 v119, v23, v19, s59
  s_waitcnt vmcnt(3)
  buffer_load_dwordx4 v[40:43], v1, s[24:27], s68 offen offset:1024 nt
  buffer_load_dwordx4 v[44:47], v1, s[24:27], s68 offen offset:1280 nt
  s_waitcnt lgkmcnt(0)
  v_mfma_f32_16x16x32_bf16 a[0:3], v[120:123], v[88:91], a[0:3]
  v_mfma_f32_16x16x32_bf16 a[4:7], v[120:123], v[92:95], a[4:7]
  s_waitcnt vmcnt(4)
  buffer_load_dwordx4 v[48:51], v1, s[24:27], s68 offen offset:1536 nt
  v_perm_b32 v56, v28, v24, s58
  v_perm_b32 v60, v28, v24, s59
  v_perm_b32 v64, v29, v25, s58
  v_perm_b32 v68, v29, v25, s59
  v_perm_b32 v72, v30, v26, s58
  v_perm_b32 v76, v30, v26, s59
  v_perm_b32 v80, v31, v27, s58
  v_perm_b32 v84, v31, v27, s59
  s_waitcnt vmcnt(4)
  buffer_load_dwordx4 v[52:55], v1, s[24:27], s68 offen offset:1792 nt
  v_mfma_f32_16x16x32_bf16 a[8:11], v[120:123], v[96:99], a[8:11]
  v_mfma_f32_16x16x32_bf16 a[12:15], v[120:123], v[100:103], a[12:15]
  s_waitcnt vmcnt(4)
  v_perm_b32 v57, v36, v32, s58
  v_perm_b32 v61, v36, v32, s59
  v_perm_b32 v65, v37, v33, s58
  v_perm_b32 v69, v37, v33, s59
  v_perm_b32 v73, v38, v34, s58
  v_perm_b32 v77, v38, v34, s59
  v_perm_b32 v81, v39, v35, s58
  v_perm_b32 v85, v39, v35, s59
  ds_read_b128 v[124:127], v5 offset:1536
  s_waitcnt vmcnt(3)
  buffer_load_dwordx4 v[8:11], v1, s[24:27], s55 offen offset:0 nt
  buffer_load_dwordx4 v[12:15], v1, s[24:27], s55 offen offset:256 nt
  v_mfma_f32_16x16x32_bf16 a[16:19], v[120:123], v[104:107], a[16:19]
  v_mfma_f32_16x16x32_bf16 a[20:23], v[120:123], v[108:111], a[20:23]
  s_waitcnt vmcnt(4)
  buffer_load_dwordx4 v[16:19], v1, s[24:27], s55 offen offset:512 nt
  v_perm_b32 v58, v44, v40, s58
  v_perm_b32 v62, v44, v40, s59
  v_perm_b32 v66, v45, v41, s58
  v_perm_b32 v70, v45, v41, s59
  v_perm_b32 v74, v46, v42, s58
  v_perm_b32 v78, v46, v42, s59
  v_perm_b32 v82, v47, v43, s58
  v_perm_b32 v86, v47, v43, s59
  s_waitcnt vmcnt(4)
  buffer_load_dwordx4 v[20:23], v1, s[24:27], s55 offen offset:768 nt
  v_mfma_f32_16x16x32_bf16 a[24:27], v[120:123], v[112:115], a[24:27]
  v_mfma_f32_16x16x32_bf16 a[28:31], v[120:123], v[116:119], a[28:31]
  s_add_u32 s68, s88, 327680
  s_waitcnt vmcnt(4)
  v_perm_b32 v59, v52, v48, s58
  v_perm_b32 v63, v52, v48, s59
  v_perm_b32 v67, v53, v49, s58
  v_perm_b32 v71, v53, v49, s59
  v_perm_b32 v75, v54, v50, s58
  v_perm_b32 v79, v54, v50, s59
  v_perm_b32 v83, v55, v51, s58
  v_perm_b32 v87, v55, v51, s59
  s_waitcnt vmcnt(3)
  buffer_load_dwordx4 v[24:27], v1, s[24:27], s55 offen offset:1024 nt
  buffer_load_dwordx4 v[28:31], v1, s[24:27], s55 offen offset:1280 nt
  s_waitcnt lgkmcnt(0)
  v_mfma_f32_16x16x32_bf16 a[0:3], v[124:127], v[56:59], a[0:3]
  v_mfma_f32_16x16x32_bf16 a[4:7], v[124:127], v[60:63], a[4:7]
  s_waitcnt vmcnt(4)
  buffer_load_dwordx4 v[32:35], v1, s[24:27], s55 offen offset:1536 nt
  v_perm_b32 v88, v12, v8, s58
  v_perm_b32 v92, v12, v8, s59
  v_perm_b32 v96, v13, v9, s58
  v_perm_b32 v100, v13, v9, s59
  v_perm_b32 v104, v14, v10, s58
  v_perm_b32 v108, v14, v10, s59
  v_perm_b32 v112, v15, v11, s58
  v_perm_b32 v116, v15, v11, s59
  s_waitcnt vmcnt(4)
  buffer_load_dwordx4 v[36:39], v1, s[24:27], s55 offen offset:1792 nt
  v_mfma_f32_16x16x32_bf16 a[8:11], v[124:127], v[64:67], a[8:11]
  v_mfma_f32_16x16x32_bf16 a[12:15], v[124:127], v[68:71], a[12:15]
  s_waitcnt vmcnt(4)
  v_perm_b32 v89, v20, v16, s58
  v_perm_b32 v93, v20, v16, s59
  v_perm_b32 v97, v21, v17, s58
  v_perm_b32 v101, v21, v17, s59
  v_perm_b32 v105, v22, v18, s58
  v_perm_b32 v109, v22, v18, s59
  v_perm_b32 v113, v23, v19, s58
  v_perm_b32 v117, v23, v19, s59
  ds_read_b128 v[120:123], v5 offset:2048
  s_waitcnt vmcnt(3)
  buffer_load_dwordx4 v[40:43], v1, s[24:27], s68 offen offset:0 nt
  buffer_load_dwordx4 v[44:47], v1, s[24:27], s68 offen offset:256 nt
  v_mfma_f32_16x16x32_bf16 a[16:19], v[124:127], v[72:75], a[16:19]
  v_mfma_f32_16x16x32_bf16 a[20:23], v[124:127], v[76:79], a[20:23]
  s_waitcnt vmcnt(4)
  buffer_load_dwordx4 v[48:51], v1, s[24:27], s68 offen offset:512 nt
  v_perm_b32 v90, v28, v24, s58
  v_perm_b32 v94, v28, v24, s59
  v_perm_b32 v98, v29, v25, s58
  v_perm_b32 v102, v29, v25, s59
  v_perm_b32 v106, v30, v26, s58
  v_perm_b32 v110, v30, v26, s59
  v_perm_b32 v114, v31, v27, s58
  v_perm_b32 v118, v31, v27, s59
  s_waitcnt vmcnt(4)
  buffer_load_dwordx4 v[52:55], v1, s[24:27], s68 offen offset:768 nt
  v_mfma_f32_16x16x32_bf16 a[24:27], v[124:127], v[80:83], a[24:27]
  v_mfma_f32_16x16x32_bf16 a[28:31], v[124:127], v[84:87], a[28:31]
  s_add_u32 s55, s88, 393216
  s_waitcnt vmcnt(4)
  v_perm_b32 v91, v36, v32, s58
  v_perm_b32 v95, v36, v32, s59
  v_perm_b32 v99, v37, v33, s58
  v_perm_b32 v103, v37, v33, s59
  v_perm_b32 v107, v38, v34, s58
  v_perm_b32 v111, v38, v34, s59
  v_perm_b32 v115, v39, v35, s58
  v_perm_b32 v119, v39, v35, s59
  s_waitcnt vmcnt(3)
  buffer_load_dwordx4 v[8:11], v1, s[24:27], s68 offen offset:1024 nt
  buffer_load_dwordx4 v[12:15], v1, s[24:27], s68 offen offset:1280 nt
  s_waitcnt lgkmcnt(0)
  v_mfma_f32_16x16x32_bf16 a[0:3], v[120:123], v[88:91], a[0:3]
  v_mfma_f32_16x16x32_bf16 a[4:7], v[120:123], v[92:95], a[4:7]
  s_waitcnt vmcnt(4)
  buffer_load_dwordx4 v[16:19], v1, s[24:27], s68 offen offset:1536 nt
  v_perm_b32 v56, v44, v40, s58
  v_perm_b32 v60, v44, v40, s59
  v_perm_b32 v64, v45, v41, s58
  v_perm_b32 v68, v45, v41, s59
  v_perm_b32 v72, v46, v42, s58
  v_perm_b32 v76, v46, v42, s59
  v_perm_b32 v80, v47, v43, s58
  v_perm_b32 v84, v47, v43, s59
  s_waitcnt vmcnt(4)
  buffer_load_dwordx4 v[20:23], v1, s[24:27], s68 offen offset:1792 nt
  v_mfma_f32_16x16x32_bf16 a[8:11], v[120:123], v[96:99], a[8:11]
  v_mfma_f32_16x16x32_bf16 a[12:15], v[120:123], v[100:103], a[12:15]
  s_waitcnt vmcnt(4)
  v_perm_b32 v57, v52, v48, s58
  v_perm_b32 v61, v52, v48, s59
  v_perm_b32 v65, v53, v49, s58
  v_perm_b32 v69, v53, v49, s59
  v_perm_b32 v73, v54, v50, s58
  v_perm_b32 v77, v54, v50, s59
  v_perm_b32 v81, v55, v51, s58
  v_perm_b32 v85, v55, v51, s59
  ds_read_b128 v[124:127], v5 offset:2560
  s_waitcnt vmcnt(3)
  buffer_load_dwordx4 v[24:27], v1, s[24:27], s55 offen offset:0 nt
  buffer_load_dwordx4 v[28:31], v1, s[24:27], s55 offen offset:256 nt
  v_mfma_f32_16x16x32_bf16 a[16:19], v[120:123], v[104:107], a[16:19]
  v_mfma_f32_16x16x32_bf16 a[20:23], v[120:123], v[108:111], a[20:23]
  s_waitcnt vmcnt(4)
  buffer_load_dwordx4 v[32:35], v1, s[24:27], s55 offen offset:512 nt
  v_perm_b32 v58, v12, v8, s58
  v_perm_b32 v62, v12, v8, s59
  v_perm_b32 v66, v13, v9, s58
  v_perm_b32 v70, v13, v9, s59
  v_perm_b32 v74, v14, v10, s58
  v_perm_b32 v78, v14, v10, s59
  v_perm_b32 v82, v15, v11, s58
  v_perm_b32 v86, v15, v11, s59
  s_waitcnt vmcnt(4)
  buffer_load_dwordx4 v[36:39], v1, s[24:27], s55 offen offset:768 nt
  v_mfma_f32_16x16x32_bf16 a[24:27], v[120:123], v[112:115], a[24:27]
  v_mfma_f32_16x16x32_bf16 a[28:31], v[120:123], v[116:119], a[28:31]
  s_add_u32 s68, s88, 458752
  s_waitcnt vmcnt(4)
  v_perm_b32 v59, v20, v16, s58
  v_perm_b32 v63, v20, v16, s59
  v_perm_b32 v67, v21, v17, s58
  v_perm_b32 v71, v21, v17, s59
  v_perm_b32 v75, v22, v18, s58
  v_perm_b32 v79, v22, v18, s59
  v_perm_b32 v83, v23, v19, s58
  v_perm_b32 v87, v23, v19, s59
  s_waitcnt vmcnt(3)
  buffer_load_dwordx4 v[40:43], v1, s[24:27], s55 offen offset:1024 nt
  buffer_load_dwordx4 v[44:47], v1, s[24:27], s55 offen offset:1280 nt
  s_waitcnt lgkmcnt(0)
  v_mfma_f32_16x16x32_bf16 a[0:3], v[124:127], v[56:59], a[0:3]
  v_mfma_f32_16x16x32_bf16 a[4:7], v[124:127], v[60:63], a[4:7]
  s_waitcnt vmcnt(4)
  buffer_load_dwordx4 v[48:51], v1, s[24:27], s55 offen offset:1536 nt
  v_perm_b32 v88, v28, v24, s58
  v_perm_b32 v92, v28, v24, s59
  v_perm_b32 v96, v29, v25, s58
  v_perm_b32 v100, v29, v25, s59
  v_perm_b32 v104, v30, v26, s58
  v_perm_b32 v108, v30, v26, s59
  v_perm_b32 v112, v31, v27, s58
  v_perm_b32 v116, v31, v27, s59
  s_waitcnt vmcnt(4)
  buffer_load_dwordx4 v[52:55], v1, s[24:27], s55 offen offset:1792 nt
  v_mfma_f32_16x16x32_bf16 a[8:11], v[124:127], v[64:67], a[8:11]
  v_mfma_f32_16x16x32_bf16 a[12:15], v[124:127], v[68:71], a[12:15]
  s_waitcnt vmcnt(4)
  v_perm_b32 v89, v36, v32, s58
  v_perm_b32 v93, v36, v32, s59
  v_perm_b32 v97, v37, v33, s58
  v_perm_b32 v101, v37, v33, s59
  v_perm_b32 v105, v38, v34, s58
  v_perm_b32 v109, v38, v34, s59
  v_perm_b32 v113, v39, v35, s58
  v_perm_b32 v117, v39, v35, s59
  ds_read_b128 v[120:123], v5 offset:3072
  s_waitcnt vmcnt(3)
  buffer_load_dwordx4 v[8:11], v1, s[24:27], s68 offen offset:0 nt
  buffer_load_dwordx4 v[12:15], v1, s[24:27], s68 offen offset:256 nt
  v_mfma_f32_16x16x32_bf16 a[16:19], v[124:127], v[72:75], a[16:19]
  v_mfma_f32_16x16x32_bf16 a[20:23], v[124:127], v[76:79], a[20:23]
  s_waitcnt vmcnt(4)
  buffer_load_dwordx4 v[16:19], v1, s[24:27], s68 offen offset:512 nt
  v_perm_b32 v90, v44, v40, s58
  v_perm_b32 v94, v44, v40, s59
  v_perm_b32 v98, v45, v41, s58
  v_perm_b32 v102, v45, v41, s59
  v_perm_b32 v106, v46, v42, s58
  v_perm_b32 v110, v46, v42, s59
  v_perm_b32 v114, v47, v43, s58
  v_perm_b32 v118, v47, v43, s59
  s_waitcnt vmcnt(4)
  buffer_load_dwordx4 v[20:23], v1, s[24:27], s68 offen offset:768 nt
  v_mfma_f32_16x16x32_bf16 a[24:27], v[124:127], v[80:83], a[24:27]
  v_mfma_f32_16x16x32_bf16 a[28:31], v[124:127], v[84:87], a[28:31]
  s_add_u32 s55, s88, 4194304
  s_waitcnt vmcnt(4)
  v_perm_b32 v91, v52, v48, s58
  v_perm_b32 v95, v52, v48, s59
  v_perm_b32 v99, v53, v49, s58
  v_perm_b32 v103, v53, v49, s59
  v_perm_b32 v107, v54, v50, s58
  v_perm_b32 v111, v54, v50, s59
  v_perm_b32 v115, v55, v51, s58
  v_perm_b32 v119, v55, v51, s59
  s_waitcnt vmcnt(3)
  buffer_load_dwordx4 v[24:27], v1, s[24:27], s68 offen offset:1024 nt
  buffer_load_dwordx4 v[28:31], v1, s[24:27], s68 offen offset:1280 nt
  s_waitcnt lgkmcnt(0)
  v_mfma_f32_16x16x32_bf16 a[0:3], v[120:123], v[88:91], a[0:3]
  v_mfma_f32_16x16x32_bf16 a[4:7], v[120:123], v[92:95], a[4:7]
  s_waitcnt vmcnt(4)
  buffer_load_dwordx4 v[32:35], v1, s[24:27], s68 offen offset:1536 nt
  v_perm_b32 v56, v12, v8, s58
  v_perm_b32 v60, v12, v8, s59
  v_perm_b32 v64, v13, v9, s58
  v_perm_b32 v68, v13, v9, s59
  v_perm_b32 v72, v14, v10, s58
  v_perm_b32 v76, v14, v10, s59
  v_perm_b32 v80, v15, v11, s58
  v_perm_b32 v84, v15, v11, s59
  s_waitcnt vmcnt(4)
  buffer_load_dwordx4 v[36:39], v1, s[24:27], s68 offen offset:1792 nt
  v_mfma_f32_16x16x32_bf16 a[8:11], v[120:123], v[96:99], a[8:11]
  v_mfma_f32_16x16x32_bf16 a[12:15], v[120:123], v[100:103], a[12:15]
  s_waitcnt vmcnt(4)
  v_perm_b32 v57, v20, v16, s58
  v_perm_b32 v61, v20, v16, s59
  v_perm_b32 v65, v21, v17, s58
  v_perm_b32 v69, v21, v17, s59
  v_perm_b32 v73, v22, v18, s58
  v_perm_b32 v77, v22, v18, s59
  v_perm_b32 v81, v23, v19, s58
  v_perm_b32 v85, v23, v19, s59
  ds_read_b128 v[124:127], v5 offset:3584
  s_waitcnt vmcnt(3)
  buffer_load_dwordx4 v[40:43], v1, s[24:27], s55 offen offset:0 nt
  buffer_load_dwordx4 v[44:47], v1, s[24:27], s55 offen offset:256 nt
  v_mfma_f32_16x16x32_bf16 a[16:19], v[120:123], v[104:107], a[16:19]
  v_mfma_f32_16x16x32_bf16 a[20:23], v[120:123], v[108:111], a[20:23]
  s_waitcnt vmcnt(4)
  buffer_load_dwordx4 v[48:51], v1, s[24:27], s55 offen offset:512 nt
  v_perm_b32 v58, v28, v24, s58
  v_perm_b32 v62, v28, v24, s59
  v_perm_b32 v66, v29, v25, s58
  v_perm_b32 v70, v29, v25, s59
  v_perm_b32 v74, v30, v26, s58
  v_perm_b32 v78, v30, v26, s59
  v_perm_b32 v82, v31, v27, s58
  v_perm_b32 v86, v31, v27, s59
  s_waitcnt vmcnt(4)
  buffer_load_dwordx4 v[52:55], v1, s[24:27], s55 offen offset:768 nt
  v_mfma_f32_16x16x32_bf16 a[24:27], v[120:123], v[112:115], a[24:27]
  v_mfma_f32_16x16x32_bf16 a[28:31], v[120:123], v[116:119], a[28:31]
  s_add_u32 s68, s88, 4259840
  s_waitcnt vmcnt(4)
  v_perm_b32 v59, v36, v32, s58
  v_perm_b32 v63, v36, v32, s59
  v_perm_b32 v67, v37, v33, s58
  v_perm_b32 v71, v37, v33, s59
  v_perm_b32 v75, v38, v34, s58
  v_perm_b32 v79, v38, v34, s59
  v_perm_b32 v83, v39, v35, s58
  v_perm_b32 v87, v39, v35, s59
  s_waitcnt vmcnt(3)
  buffer_load_dwordx4 v[8:11], v1, s[24:27], s55 offen offset:1024 nt
  buffer_load_dwordx4 v[12:15], v1, s[24:27], s55 offen offset:1280 nt
  s_waitcnt lgkmcnt(0)
  s_barrier
  v_mfma_f32_16x16x32_bf16 a[0:3], v[124:127], v[56:59], a[0:3]
  v_mfma_f32_16x16x32_bf16 a[4:7], v[124:127], v[60:63], a[4:7]
  s_waitcnt vmcnt(4)
  buffer_load_dwordx4 v[16:19], v1, s[24:27], s55 offen offset:1536 nt
  v_perm_b32 v88, v44, v40, s58
  v_perm_b32 v92, v44, v40, s59
  v_perm_b32 v96, v45, v41, s58
  v_perm_b32 v100, v45, v41, s59
  v_perm_b32 v104, v46, v42, s58
  v_perm_b32 v108, v46, v42, s59
  v_perm_b32 v112, v47, v43, s58
  v_perm_b32 v116, v47, v43, s59
  s_waitcnt vmcnt(4)
  buffer_load_dwordx4 v[20:23], v1, s[24:27], s55 offen offset:1792 nt
  v_mfma_f32_16x16x32_bf16 a[8:11], v[124:127], v[64:67], a[8:11]
  v_mfma_f32_16x16x32_bf16 a[12:15], v[124:127], v[68:71], a[12:15]
  s_waitcnt vmcnt(4)
  v_perm_b32 v89, v52, v48, s58
  v_perm_b32 v93, v52, v48, s59
  v_perm_b32 v97, v53, v49, s58
  v_perm_b32 v101, v53, v49, s59
  v_perm_b32 v105, v54, v50, s58
  v_perm_b32 v109, v54, v50, s59
  v_perm_b32 v113, v55, v51, s58
  v_perm_b32 v117, v55, v51, s59
  ds_read_b128 v[120:123], v5 offset:0
  s_waitcnt vmcnt(3)
  buffer_load_dwordx4 v[24:27], v1, s[24:27], s68 offen offset:0 nt
  buffer_load_dwordx4 v[28:31], v1, s[24:27], s68 offen offset:256 nt
  v_mfma_f32_16x16x32_bf16 a[16:19], v[124:127], v[72:75], a[16:19]
  v_mfma_f32_16x16x32_bf16 a[20:23], v[124:127], v[76:79], a[20:23]
  s_waitcnt vmcnt(4)
  buffer_load_dwordx4 v[32:35], v1, s[24:27], s68 offen offset:512 nt
  v_perm_b32 v90, v12, v8, s58
  v_perm_b32 v94, v12, v8, s59
  v_perm_b32 v98, v13, v9, s58
  v_perm_b32 v102, v13, v9, s59
  v_perm_b32 v106, v14, v10, s58
  v_perm_b32 v110, v14, v10, s59
  v_perm_b32 v114, v15, v11, s58
  v_perm_b32 v118, v15, v11, s59
  s_waitcnt vmcnt(4)
  buffer_load_dwordx4 v[36:39], v1, s[24:27], s68 offen offset:768 nt
  v_mfma_f32_16x16x32_bf16 a[24:27], v[124:127], v[80:83], a[24:27]
  v_mfma_f32_16x16x32_bf16 a[28:31], v[124:127], v[84:87], a[28:31]
  s_add_u32 s55, s88, 4325376
  s_waitcnt vmcnt(4)
  v_perm_b32 v91, v20, v16, s58
  v_perm_b32 v95, v20, v16, s59
  v_perm_b32 v99, v21, v17, s58
  v_perm_b32 v103, v21, v17, s59
  v_perm_b32 v107, v22, v18, s58
  v_perm_b32 v111, v22, v18, s59
  v_perm_b32 v115, v23, v19, s58
  v_perm_b32 v119, v23, v19, s59
  s_mov_b64 exec, 0xffff
  ds_write_b32 v4, a0 offset:0
  ds_write_b32 v4, a4 offset:4
  ds_write_b32 v4, a8 offset:8
  ds_write_b32 v4, a12 offset:12
  ds_write_b32 v4, a16 offset:16
  ds_write_b32 v4, a20 offset:20
  ds_write_b32 v4, a24 offset:24
  ds_write_b32 v4, a28 offset:28
  s_mov_b64 exec, -1
  s_waitcnt vmcnt(3)
  buffer_load_dwordx4 v[40:43], v1, s[24:27], s68 offen offset:1024 nt
  buffer_load_dwordx4 v[44:47], v1, s[24:27], s68 offen offset:1280 nt
  s_waitcnt lgkmcnt(0)
  v_mfma_f32_16x16x32_bf16 a[0:3], v[120:123], v[88:91], 0
  v_mfma_f32_16x16x32_bf16 a[4:7], v[120:123], v[92:95], 0
  s_waitcnt vmcnt(4)
  buffer_load_dwordx4 v[48:51], v1, s[24:27], s68 offen offset:1536 nt
  v_perm_b32 v56, v28, v24, s58
  v_perm_b32 v60, v28, v24, s59
  v_perm_b32 v64, v29, v25, s58
  v_perm_b32 v68, v29, v25, s59
  v_perm_b32 v72, v30, v26, s58
  v_perm_b32 v76, v30, v26, s59
  v_perm_b32 v80, v31, v27, s58
  v_perm_b32 v84, v31, v27, s59
  s_waitcnt vmcnt(4)
  buffer_load_dwordx4 v[52:55], v1, s[24:27], s68 offen offset:1792 nt
  v_mfma_f32_16x16x32_bf16 a[8:11], v[120:123], v[96:99], 0
  v_mfma_f32_16x16x32_bf16 a[12:15], v[120:123], v[100:103], 0
  s_waitcnt vmcnt(4)
  v_perm_b32 v57, v36, v32, s58
  v_perm_b32 v61, v36, v32, s59
  v_perm_b32 v65, v37, v33, s58
  v_perm_b32 v69, v37, v33, s59
  v_perm_b32 v73, v38, v34, s58
  v_perm_b32 v77, v38, v34, s59
  v_perm_b32 v81, v39, v35, s58
  v_perm_b32 v85, v39, v35, s59
  ds_read_b128 v[124:127], v5 offset:512
  s_waitcnt vmcnt(3)
  buffer_load_dwordx4 v[8:11], v1, s[24:27], s55 offen offset:0 nt
  buffer_load_dwordx4 v[12:15], v1, s[24:27], s55 offen offset:256 nt
  v_mfma_f32_16x16x32_bf16 a[16:19], v[120:123], v[104:107], 0
  v_mfma_f32_16x16x32_bf16 a[20:23], v[120:123], v[108:111], 0
  s_waitcnt vmcnt(4)
  buffer_load_dwordx4 v[16:19], v1, s[24:27], s55 offen offset:512 nt
  v_perm_b32 v58, v44, v40, s58
  v_perm_b32 v62, v44, v40, s59
  v_perm_b32 v66, v45, v41, s58
  v_perm_b32 v70, v45, v41, s59
  v_perm_b32 v74, v46, v42, s58
  v_perm_b32 v78, v46, v42, s59
  v_perm_b32 v82, v47, v43, s58
  v_perm_b32 v86, v47, v43, s59
  s_waitcnt vmcnt(4)
  buffer_load_dwordx4 v[20:23], v1, s[24:27], s55 offen offset:768 nt
  v_mfma_f32_16x16x32_bf16 a[24:27], v[120:123], v[112:115], 0
  v_mfma_f32_16x16x32_bf16 a[28:31], v[120:123], v[116:119], 0
  s_add_u32 s68, s88, 4390912
  s_waitcnt vmcnt(4)
  v_perm_b32 v59, v52, v48, s58
  v_perm_b32 v63, v52, v48, s59
  v_perm_b32 v67, v53, v49, s58
  v_perm_b32 v71, v53, v49, s59
  v_perm_b32 v75, v54, v50, s58
  v_perm_b32 v79, v54, v50, s59
  v_perm_b32 v83, v55, v51, s58
  v_perm_b32 v87, v55, v51, s59
  s_waitcnt vmcnt(3)
  buffer_load_dwordx4 v[24:27], v1, s[24:27], s55 offen offset:1024 nt
  buffer_load_dwordx4 v[28:31], v1, s[24:27], s55 offen offset:1280 nt
  s_waitcnt lgkmcnt(0)
  v_mfma_f32_16x16x32_bf16 a[0:3], v[124:127], v[56:59], a[0:3]
  v_mfma_f32_16x16x32_bf16 a[4:7], v[124:127], v[60:63], a[4:7]
  s_waitcnt vmcnt(4)
  buffer_load_dwordx4 v[32:35], v1, s[24:27], s55 offen offset:1536 nt
  v_perm_b32 v88, v12, v8, s58
  v_perm_b32 v92, v12, v8, s59
  v_perm_b32 v96, v13, v9, s58
  v_perm_b32 v100, v13, v9, s59
  v_perm_b32 v104, v14, v10, s58
  v_perm_b32 v108, v14, v10, s59
  v_perm_b32 v112, v15, v11, s58
  v_perm_b32 v116, v15, v11, s59
  s_waitcnt vmcnt(4)
  buffer_load_dwordx4 v[36:39], v1, s[24:27], s55 offen offset:1792 nt
  v_mfma_f32_16x16x32_bf16 a[8:11], v[124:127], v[64:67], a[8:11]
  v_mfma_f32_16x16x32_bf16 a[12:15], v[124:127], v[68:71], a[12:15]
  s_waitcnt vmcnt(4)
  v_perm_b32 v89, v20, v16, s58
  v_perm_b32 v93, v20, v16, s59
  v_perm_b32 v97, v21, v17, s58
  v_perm_b32 v101, v21, v17, s59
  v_perm_b32 v105, v22, v18, s58
  v_perm_b32 v109, v22, v18, s59
  v_perm_b32 v113, v23, v19, s58
  v_perm_b32 v117, v23, v19, s59
  ds_read_b128 v[120:123], v5 offset:1024
  s_waitcnt vmcnt(3)
  buffer_load_dwordx4 v[40:43], v1, s[24:27], s68 offen offset:0 nt
  buffer_load_dwordx4 v[44:47], v1, s[24:27], s68 offen offset:256 nt
  v_mfma_f32_16x16x32_bf16 a[16:19], v[124:127], v[72:75], a[16:19]
  v_mfma_f32_16x16x32_bf16 a[20:23], v[124:127], v[76:79], a[20:23]
  s_waitcnt vmcnt(4)
  buffer_load_dwordx4 v[48:51], v1, s[24:27], s68 offen offset:512 nt
  v_perm_b32 v90, v28, v24, s58
  v_perm_b32 v94, v28, v24, s59
  v_perm_b32 v98, v29, v25, s58
  v_perm_b32 v102, v29, v25, s59
  v_perm_b32 v106, v30, v26, s58
  v_perm_b32 v110, v30, v26, s59
  v_perm_b32 v114, v31, v27, s58
  v_perm_b32 v118, v31, v27, s59
  s_waitcnt vmcnt(4)
  buffer_load_dwordx4 v[52:55], v1, s[24:27], s68 offen offset:768 nt
  v_mfma_f32_16x16x32_bf16 a[24:27], v[124:127], v[80:83], a[24:27]
  v_mfma_f32_16x16x32_bf16 a[28:31], v[124:127], v[84:87], a[28:31]
  s_add_u32 s55, s88, 4456448
  s_waitcnt vmcnt(4)
  v_perm_b32 v91, v36, v32, s58
  v_perm_b32 v95, v36, v32, s59
  v_perm_b32 v99, v37, v33, s58
  v_perm_b32 v103, v37, v33, s59
  v_perm_b32 v107, v38, v34, s58
  v_perm_b32 v111, v38, v34, s59
  v_perm_b32 v115, v39, v35, s58
  v_perm_b32 v119, v39, v35, s59
  s_waitcnt vmcnt(3)
  buffer_load_dwordx4 v[8:11], v1, s[24:27], s68 offen offset:1024 nt
  buffer_load_dwordx4 v[12:15], v1, s[24:27], s68 offen offset:1280 nt
  s_waitcnt lgkmcnt(0)
  v_mfma_f32_16x16x32_bf16 a[0:3], v[120:123], v[88:91], a[0:3]
  v_mfma_f32_16x16x32_bf16 a[4:7], v[120:123], v[92:95], a[4:7]
  s_waitcnt vmcnt(4)
  buffer_load_dwordx4 v[16:19], v1, s[24:27], s68 offen offset:1536 nt
  v_perm_b32 v56, v44, v40, s58
  v_perm_b32 v60, v44, v40, s59
  v_perm_b32 v64, v45, v41, s58
  v_perm_b32 v68, v45, v41, s59
  v_perm_b32 v72, v46, v42, s58
  v_perm_b32 v76, v46, v42, s59
  v_perm_b32 v80, v47, v43, s58
  v_perm_b32 v84, v47, v43, s59
  s_waitcnt vmcnt(4)
  buffer_load_dwordx4 v[20:23], v1, s[24:27], s68 offen offset:1792 nt
  v_mfma_f32_16x16x32_bf16 a[8:11], v[120:123], v[96:99], a[8:11]
  v_mfma_f32_16x16x32_bf16 a[12:15], v[120:123], v[100:103], a[12:15]
  s_waitcnt vmcnt(4)
  v_perm_b32 v57, v52, v48, s58
  v_perm_b32 v61, v52, v48, s59
  v_perm_b32 v65, v53, v49, s58
  v_perm_b32 v69, v53, v49, s59
  v_perm_b32 v73, v54, v50, s58
  v_perm_b32 v77, v54, v50, s59
  v_perm_b32 v81, v55, v51, s58
  v_perm_b32 v85, v55, v51, s59
  ds_read_b128 v[124:127], v5 offset:1536
  s_waitcnt vmcnt(3)
  buffer_load_dwordx4 v[24:27], v1, s[24:27], s55 offen offset:0 nt
  buffer_load_dwordx4 v[28:31], v1, s[24:27], s55 offen offset:256 nt
  v_mfma_f32_16x16x32_bf16 a[16:19], v[120:123], v[104:107], a[16:19]
  v_mfma_f32_16x16x32_bf16 a[20:23], v[120:123], v[108:111], a[20:23]
  s_waitcnt vmcnt(4)
  buffer_load_dwordx4 v[32:35], v1, s[24:27], s55 offen offset:512 nt
  v_perm_b32 v58, v12, v8, s58
  v_perm_b32 v62, v12, v8, s59
  v_perm_b32 v66, v13, v9, s58
  v_perm_b32 v70, v13, v9, s59
  v_perm_b32 v74, v14, v10, s58
  v_perm_b32 v78, v14, v10, s59
  v_perm_b32 v82, v15, v11, s58
  v_perm_b32 v86, v15, v11, s59
  s_waitcnt vmcnt(4)
  buffer_load_dwordx4 v[36:39], v1, s[24:27], s55 offen offset:768 nt
  v_mfma_f32_16x16x32_bf16 a[24:27], v[120:123], v[112:115], a[24:27]
  v_mfma_f32_16x16x32_bf16 a[28:31], v[120:123], v[116:119], a[28:31]
  s_add_u32 s68, s88, 4521984
  s_waitcnt vmcnt(4)
  v_perm_b32 v59, v20, v16, s58
  v_perm_b32 v63, v20, v16, s59
  v_perm_b32 v67, v21, v17, s58
  v_perm_b32 v71, v21, v17, s59
  v_perm_b32 v75, v22, v18, s58
  v_perm_b32 v79, v22, v18, s59
  v_perm_b32 v83, v23, v19, s58
  v_perm_b32 v87, v23, v19, s59
  s_waitcnt vmcnt(3)
  buffer_load_dwordx4 v[40:43], v1, s[24:27], s55 offen offset:1024 nt
  buffer_load_dwordx4 v[44:47], v1, s[24:27], s55 offen offset:1280 nt
  s_waitcnt lgkmcnt(0)
  s_barrier
  v_mfma_f32_16x16x32_bf16 a[0:3], v[124:127], v[56:59], a[0:3]
  v_mfma_f32_16x16x32_bf16 a[4:7], v[124:127], v[60:63], a[4:7]
  s_waitcnt vmcnt(4)
  buffer_load_dwordx4 v[48:51], v1, s[24:27], s55 offen offset:1536 nt
  v_perm_b32 v88, v28, v24, s58
  v_perm_b32 v92, v28, v24, s59
  v_perm_b32 v96, v29, v25, s58
  v_perm_b32 v100, v29, v25, s59
  v_perm_b32 v104, v30, v26, s58
  v_perm_b32 v108, v30, v26, s59
  v_perm_b32 v112, v31, v27, s58
  v_perm_b32 v116, v31, v27, s59
  s_waitcnt vmcnt(4)
  buffer_load_dwordx4 v[52:55], v1, s[24:27], s55 offen offset:1792 nt
  v_mfma_f32_16x16x32_bf16 a[8:11], v[124:127], v[64:67], a[8:11]
  v_mfma_f32_16x16x32_bf16 a[12:15], v[124:127], v[68:71], a[12:15]
  s_waitcnt vmcnt(4)
  v_perm_b32 v89, v36, v32, s58
  v_perm_b32 v93, v36, v32, s59
  v_perm_b32 v97, v37, v33, s58
  v_perm_b32 v101, v37, v33, s59
  v_perm_b32 v105, v38, v34, s58
  v_perm_b32 v109, v38, v34, s59
  v_perm_b32 v113, v39, v35, s58
  v_perm_b32 v117, v39, v35, s59
  ds_read_b128 v[120:123], v5 offset:2048
  s_waitcnt vmcnt(3)
  buffer_load_dwordx4 v[8:11], v1, s[24:27], s68 offen offset:0 nt
  buffer_load_dwordx4 v[12:15], v1, s[24:27], s68 offen offset:256 nt
  v_mfma_f32_16x16x32_bf16 a[16:19], v[124:127], v[72:75], a[16:19]
  v_mfma_f32_16x16x32_bf16 a[20:23], v[124:127], v[76:79], a[20:23]
  s_waitcnt vmcnt(4)
  buffer_load_dwordx4 v[16:19], v1, s[24:27], s68 offen offset:512 nt
  v_perm_b32 v90, v44, v40, s58
  v_perm_b32 v94, v44, v40, s59
  v_perm_b32 v98, v45, v41, s58
  v_perm_b32 v102, v45, v41, s59
  v_perm_b32 v106, v46, v42, s58
  v_perm_b32 v110, v46, v42, s59
  v_perm_b32 v114, v47, v43, s58
  v_perm_b32 v118, v47, v43, s59
  s_waitcnt vmcnt(4)
  buffer_load_dwordx4 v[20:23], v1, s[24:27], s68 offen offset:768 nt
  v_mfma_f32_16x16x32_bf16 a[24:27], v[124:127], v[80:83], a[24:27]
  v_mfma_f32_16x16x32_bf16 a[28:31], v[124:127], v[84:87], a[28:31]
  s_add_u32 s55, s88, 4587520
  s_waitcnt vmcnt(4)
  v_perm_b32 v91, v52, v48, s58
  v_perm_b32 v95, v52, v48, s59
  v_perm_b32 v99, v53, v49, s58
  v_perm_b32 v103, v53, v49, s59
  v_perm_b32 v107, v54, v50, s58
  v_perm_b32 v111, v54, v50, s59
  v_perm_b32 v115, v55, v51, s58
  v_perm_b32 v119, v55, v51, s59
  s_waitcnt vmcnt(3)
  buffer_load_dwordx4 v[24:27], v1, s[24:27], s68 offen offset:1024 nt
  buffer_load_dwordx4 v[28:31], v1, s[24:27], s68 offen offset:1280 nt
  s_waitcnt lgkmcnt(0)
  v_mfma_f32_16x16x32_bf16 a[0:3], v[120:123], v[88:91], a[0:3]
  v_mfma_f32_16x16x32_bf16 a[4:7], v[120:123], v[92:95], a[4:7]
  s_waitcnt vmcnt(4)
  buffer_load_dwordx4 v[32:35], v1, s[24:27], s68 offen offset:1536 nt
  v_perm_b32 v56, v12, v8, s58
  v_perm_b32 v60, v12, v8, s59
  v_perm_b32 v64, v13, v9, s58
  v_perm_b32 v68, v13, v9, s59
  v_perm_b32 v72, v14, v10, s58
  v_perm_b32 v76, v14, v10, s59
  v_perm_b32 v80, v15, v11, s58
  v_perm_b32 v84, v15, v11, s59
  s_waitcnt vmcnt(4)
  buffer_load_dwordx4 v[36:39], v1, s[24:27], s68 offen offset:1792 nt
  v_mfma_f32_16x16x32_bf16 a[8:11], v[120:123], v[96:99], a[8:11]
  v_mfma_f32_16x16x32_bf16 a[12:15], v[120:123], v[100:103], a[12:15]
  s_waitcnt vmcnt(4)
  v_perm_b32 v57, v20, v16, s58
  v_perm_b32 v61, v20, v16, s59
  v_perm_b32 v65, v21, v17, s58
  v_perm_b32 v69, v21, v17, s59
  v_perm_b32 v73, v22, v18, s58
  v_perm_b32 v77, v22, v18, s59
  v_perm_b32 v81, v23, v19, s58
  v_perm_b32 v85, v23, v19, s59
  ds_read_b128 v[124:127], v5 offset:2560
  s_waitcnt vmcnt(3)
  buffer_load_dwordx4 v[40:43], v1, s[24:27], s55 offen offset:0 nt
  buffer_load_dwordx4 v[44:47], v1, s[24:27], s55 offen offset:256 nt
  v_mfma_f32_16x16x32_bf16 a[16:19], v[120:123], v[104:107], a[16:19]
  v_mfma_f32_16x16x32_bf16 a[20:23], v[120:123], v[108:111], a[20:23]
  s_waitcnt vmcnt(4)
  buffer_load_dwordx4 v[48:51], v1, s[24:27], s55 offen offset:512 nt
  v_perm_b32 v58, v28, v24, s58
  v_perm_b32 v62, v28, v24, s59
  v_perm_b32 v66, v29, v25, s58
  v_perm_b32 v70, v29, v25, s59
  v_perm_b32 v74, v30, v26, s58
  v_perm_b32 v78, v30, v26, s59
  v_perm_b32 v82, v31, v27, s58
  v_perm_b32 v86, v31, v27, s59
  s_waitcnt vmcnt(4)
  buffer_load_dwordx4 v[52:55], v1, s[24:27], s55 offen offset:768 nt
  v_mfma_f32_16x16x32_bf16 a[24:27], v[120:123], v[112:115], a[24:27]
  v_mfma_f32_16x16x32_bf16 a[28:31], v[120:123], v[116:119], a[28:31]
  s_add_u32 s68, s88, 4653056
  s_waitcnt vmcnt(4)
  v_perm_b32 v59, v36, v32, s58
  v_perm_b32 v63, v36, v32, s59
  v_perm_b32 v67, v37, v33, s58
  v_perm_b32 v71, v37, v33, s59
  v_perm_b32 v75, v38, v34, s58
  v_perm_b32 v79, v38, v34, s59
  v_perm_b32 v83, v39, v35, s58
  v_perm_b32 v87, v39, v35, s59
  s_waitcnt vmcnt(3)
  buffer_load_dwordx4 v[8:11], v1, s[24:27], s55 offen offset:1024 nt
  buffer_load_dwordx4 v[12:15], v1, s[24:27], s55 offen offset:1280 nt
  s_waitcnt lgkmcnt(0)
  v_mfma_f32_16x16x32_bf16 a[0:3], v[124:127], v[56:59], a[0:3]
  v_mfma_f32_16x16x32_bf16 a[4:7], v[124:127], v[60:63], a[4:7]
  s_waitcnt vmcnt(4)
  buffer_load_dwordx4 v[16:19], v1, s[24:27], s55 offen offset:1536 nt
  v_perm_b32 v88, v44, v40, s58
  v_perm_b32 v92, v44, v40, s59
  v_perm_b32 v96, v45, v41, s58
  v_perm_b32 v100, v45, v41, s59
  v_perm_b32 v104, v46, v42, s58
  v_perm_b32 v108, v46, v42, s59
  v_perm_b32 v112, v47, v43, s58
  v_perm_b32 v116, v47, v43, s59
  s_waitcnt vmcnt(4)
  buffer_load_dwordx4 v[20:23], v1, s[24:27], s55 offen offset:1792 nt
  v_mfma_f32_16x16x32_bf16 a[8:11], v[124:127], v[64:67], a[8:11]
  v_mfma_f32_16x16x32_bf16 a[12:15], v[124:127], v[68:71], a[12:15]
  s_waitcnt vmcnt(4)
  v_perm_b32 v89, v52, v48, s58
  v_perm_b32 v93, v52, v48, s59
  v_perm_b32 v97, v53, v49, s58
  v_perm_b32 v101, v53, v49, s59
  v_perm_b32 v105, v54, v50, s58
  v_perm_b32 v109, v54, v50, s59
  v_perm_b32 v113, v55, v51, s58
  v_perm_b32 v117, v55, v51, s59
  ds_read_b128 v[120:123], v5 offset:3072
  s_waitcnt vmcnt(3)
  buffer_load_dwordx4 v[24:27], v1, s[24:27], s68 offen offset:0 nt
  buffer_load_dwordx4 v[28:31], v1, s[24:27], s68 offen offset:256 nt
  v_mfma_f32_16x16x32_bf16 a[16:19], v[124:127], v[72:75], a[16:19]
  v_mfma_f32_16x16x32_bf16 a[20:23], v[124:127], v[76:79], a[20:23]
  s_waitcnt vmcnt(4)
  buffer_load_dwordx4 v[32:35], v1, s[24:27], s68 offen offset:512 nt
  v_perm_b32 v90, v12, v8, s58
  v_perm_b32 v94, v12, v8, s59
  v_perm_b32 v98, v13, v9, s58
  v_perm_b32 v102, v13, v9, s59
  v_perm_b32 v106, v14, v10, s58
  v_perm_b32 v110, v14, v10, s59
  v_perm_b32 v114, v15, v11, s58
  v_perm_b32 v118, v15, v11, s59
  s_waitcnt vmcnt(4)
  buffer_load_dwordx4 v[36:39], v1, s[24:27], s68 offen offset:768 nt
  v_mfma_f32_16x16x32_bf16 a[24:27], v[124:127], v[80:83], a[24:27]
  v_mfma_f32_16x16x32_bf16 a[28:31], v[124:127], v[84:87], a[28:31]
  s_add_u32 s55, s88, 8388608
  s_waitcnt vmcnt(4)
  v_perm_b32 v91, v20, v16, s58
  v_perm_b32 v95, v20, v16, s59
  v_perm_b32 v99, v21, v17, s58
  v_perm_b32 v103, v21, v17, s59
  v_perm_b32 v107, v22, v18, s58
  v_perm_b32 v111, v22, v18, s59
  v_perm_b32 v115, v23, v19, s58
  v_perm_b32 v119, v23, v19, s59
  s_waitcnt vmcnt(3)
  buffer_load_dwordx4 v[40:43], v1, s[24:27], s68 offen offset:1024 nt
  buffer_load_dwordx4 v[44:47], v1, s[24:27], s68 offen offset:1280 nt
  s_waitcnt lgkmcnt(0)
  v_mfma_f32_16x16x32_bf16 a[0:3], v[120:123], v[88:91], a[0:3]
  v_mfma_f32_16x16x32_bf16 a[4:7], v[120:123], v[92:95], a[4:7]
  s_waitcnt vmcnt(4)
  buffer_load_dwordx4 v[48:51], v1, s[24:27], s68 offen offset:1536 nt
  v_perm_b32 v56, v28, v24, s58
  v_perm_b32 v60, v28, v24, s59
  v_perm_b32 v64, v29, v25, s58
  v_perm_b32 v68, v29, v25, s59
  v_perm_b32 v72, v30, v26, s58
  v_perm_b32 v76, v30, v26, s59
  v_perm_b32 v80, v31, v27, s58
  v_perm_b32 v84, v31, v27, s59
  s_waitcnt vmcnt(4)
  buffer_load_dwordx4 v[52:55], v1, s[24:27], s68 offen offset:1792 nt
  v_mfma_f32_16x16x32_bf16 a[8:11], v[120:123], v[96:99], a[8:11]
  v_mfma_f32_16x16x32_bf16 a[12:15], v[120:123], v[100:103], a[12:15]
  s_waitcnt vmcnt(4)
  v_perm_b32 v57, v36, v32, s58
  v_perm_b32 v61, v36, v32, s59
  v_perm_b32 v65, v37, v33, s58
  v_perm_b32 v69, v37, v33, s59
  v_perm_b32 v73, v38, v34, s58
  v_perm_b32 v77, v38, v34, s59
  v_perm_b32 v81, v39, v35, s58
  v_perm_b32 v85, v39, v35, s59
  ds_read_b128 v[124:127], v5 offset:3584
  s_waitcnt vmcnt(3)
  buffer_load_dwordx4 v[8:11], v1, s[24:27], s55 offen offset:0 nt
  buffer_load_dwordx4 v[12:15], v1, s[24:27], s55 offen offset:256 nt
  v_mfma_f32_16x16x32_bf16 a[16:19], v[120:123], v[104:107], a[16:19]
  v_mfma_f32_16x16x32_bf16 a[20:23], v[120:123], v[108:111], a[20:23]
  s_waitcnt vmcnt(4)
  buffer_load_dwordx4 v[16:19], v1, s[24:27], s55 offen offset:512 nt
  v_perm_b32 v58, v44, v40, s58
  v_perm_b32 v62, v44, v40, s59
  v_perm_b32 v66, v45, v41, s58
  v_perm_b32 v70, v45, v41, s59
  v_perm_b32 v74, v46, v42, s58
  v_perm_b32 v78, v46, v42, s59
  v_perm_b32 v82, v47, v43, s58
  v_perm_b32 v86, v47, v43, s59
  s_waitcnt vmcnt(4)
  buffer_load_dwordx4 v[20:23], v1, s[24:27], s55 offen offset:768 nt
  v_mfma_f32_16x16x32_bf16 a[24:27], v[120:123], v[112:115], a[24:27]
  v_mfma_f32_16x16x32_bf16 a[28:31], v[120:123], v[116:119], a[28:31]
  s_add_u32 s68, s88, 8454144
  s_waitcnt vmcnt(4)
  v_perm_b32 v59, v52, v48, s58
  v_perm_b32 v63, v52, v48, s59
  v_perm_b32 v67, v53, v49, s58
  v_perm_b32 v71, v53, v49, s59
  v_perm_b32 v75, v54, v50, s58
  v_perm_b32 v79, v54, v50, s59
  v_perm_b32 v83, v55, v51, s58
  v_perm_b32 v87, v55, v51, s59
  s_waitcnt vmcnt(3)
  buffer_load_dwordx4 v[24:27], v1, s[24:27], s55 offen offset:1024 nt
  buffer_load_dwordx4 v[28:31], v1, s[24:27], s55 offen offset:1280 nt
  s_waitcnt lgkmcnt(0)
  s_barrier
  v_mfma_f32_16x16x32_bf16 a[0:3], v[124:127], v[56:59], a[0:3]
  v_mfma_f32_16x16x32_bf16 a[4:7], v[124:127], v[60:63], a[4:7]
  s_waitcnt vmcnt(4)
  buffer_load_dwordx4 v[32:35], v1, s[24:27], s55 offen offset:1536 nt
  v_perm_b32 v88, v12, v8, s58
  v_perm_b32 v92, v12, v8, s59
  v_perm_b32 v96, v13, v9, s58
  v_perm_b32 v100, v13, v9, s59
  v_perm_b32 v104, v14, v10, s58
  v_perm_b32 v108, v14, v10, s59
  v_perm_b32 v112, v15, v11, s58
  v_perm_b32 v116, v15, v11, s59
  s_waitcnt vmcnt(4)
  buffer_load_dwordx4 v[36:39], v1, s[24:27], s55 offen offset:1792 nt
  v_mfma_f32_16x16x32_bf16 a[8:11], v[124:127], v[64:67], a[8:11]
  v_mfma_f32_16x16x32_bf16 a[12:15], v[124:127], v[68:71], a[12:15]
  s_waitcnt vmcnt(4)
  v_perm_b32 v89, v20, v16, s58
  v_perm_b32 v93, v20, v16, s59
  v_perm_b32 v97, v21, v17, s58
  v_perm_b32 v101, v21, v17, s59
  v_perm_b32 v105, v22, v18, s58
  v_perm_b32 v109, v22, v18, s59
  v_perm_b32 v113, v23, v19, s58
  v_perm_b32 v117, v23, v19, s59
  ds_read_b128 v[120:123], v5 offset:4096
  s_waitcnt vmcnt(3)
  buffer_load_dwordx4 v[40:43], v1, s[24:27], s68 offen offset:0 nt
  buffer_load_dwordx4 v[44:47], v1, s[24:27], s68 offen offset:256 nt
  v_mfma_f32_16x16x32_bf16 a[16:19], v[124:127], v[72:75], a[16:19]
  v_mfma_f32_16x16x32_bf16 a[20:23], v[124:127], v[76:79], a[20:23]
  s_waitcnt vmcnt(4)
  buffer_load_dwordx4 v[48:51], v1, s[24:27], s68 offen offset:512 nt
  v_perm_b32 v90, v28, v24, s58
  v_perm_b32 v94, v28, v24, s59
  v_perm_b32 v98, v29, v25, s58
  v_perm_b32 v102, v29, v25, s59
  v_perm_b32 v106, v30, v26, s58
  v_perm_b32 v110, v30, v26, s59
  v_perm_b32 v114, v31, v27, s58
  v_perm_b32 v118, v31, v27, s59
  s_waitcnt vmcnt(4)
  buffer_load_dwordx4 v[52:55], v1, s[24:27], s68 offen offset:768 nt
  v_mfma_f32_16x16x32_bf16 a[24:27], v[124:127], v[80:83], a[24:27]
  v_mfma_f32_16x16x32_bf16 a[28:31], v[124:127], v[84:87], a[28:31]
  s_add_u32 s55, s88, 8519680
  s_waitcnt vmcnt(4)
  v_perm_b32 v91, v36, v32, s58
  v_perm_b32 v95, v36, v32, s59
  v_perm_b32 v99, v37, v33, s58
  v_perm_b32 v103, v37, v33, s59
  v_perm_b32 v107, v38, v34, s58
  v_perm_b32 v111, v38, v34, s59
  v_perm_b32 v115, v39, v35, s58
  v_perm_b32 v119, v39, v35, s59
  s_mov_b64 exec, 0xffff
  ds_write_b32 v4, a1 offset:2048
  ds_write_b32 v4, a5 offset:2052
  ds_write_b32 v4, a9 offset:2056
  ds_write_b32 v4, a13 offset:2060
  ds_write_b32 v4, a17 offset:2064
  ds_write_b32 v4, a21 offset:2068
  ds_write_b32 v4, a25 offset:2072
  ds_write_b32 v4, a29 offset:2076
  s_mov_b64 exec, -1
  s_waitcnt vmcnt(3)
  buffer_load_dwordx4 v[8:11], v1, s[24:27], s68 offen offset:1024 nt
  buffer_load_dwordx4 v[12:15], v1, s[24:27], s68 offen offset:1280 nt
  s_waitcnt lgkmcnt(0)
  v_mfma_f32_16x16x32_bf16 a[0:3], v[120:123], v[88:91], 0
  v_mfma_f32_16x16x32_bf16 a[4:7], v[120:123], v[92:95], 0
  s_waitcnt vmcnt(4)
  buffer_load_dwordx4 v[16:19], v1, s[24:27], s68 offen offset:1536 nt
  v_perm_b32 v56, v44, v40, s58
  v_perm_b32 v60, v44, v40, s59
  v_perm_b32 v64, v45, v41, s58
  v_perm_b32 v68, v45, v41, s59
  v_perm_b32 v72, v46, v42, s58
  v_perm_b32 v76, v46, v42, s59
  v_perm_b32 v80, v47, v43, s58
  v_perm_b32 v84, v47, v43, s59
  s_waitcnt vmcnt(4)
  buffer_load_dwordx4 v[20:23], v1, s[24:27], s68 offen offset:1792 nt
  v_mfma_f32_16x16x32_bf16 a[8:11], v[120:123], v[96:99], 0
  v_mfma_f32_16x16x32_bf16 a[12:15], v[120:123], v[100:103], 0
  s_waitcnt vmcnt(4)
  v_perm_b32 v57, v52, v48, s58
  v_perm_b32 v61, v52, v48, s59
  v_perm_b32 v65, v53, v49, s58
  v_perm_b32 v69, v53, v49, s59
  v_perm_b32 v73, v54, v50, s58
  v_perm_b32 v77, v54, v50, s59
  v_perm_b32 v81, v55, v51, s58
  v_perm_b32 v85, v55, v51, s59
  ds_read_b128 v[124:127], v5 offset:4608
  s_waitcnt vmcnt(3)
  buffer_load_dwordx4 v[24:27], v1, s[24:27], s55 offen offset:0 nt
  buffer_load_dwordx4 v[28:31], v1, s[24:27], s55 offen offset:256 nt
  v_mfma_f32_16x16x32_bf16 a[16:19], v[120:123], v[104:107], 0
  v_mfma_f32_16x16x32_bf16 a[20:23], v[120:123], v[108:111], 0
  s_waitcnt vmcnt(4)
  buffer_load_dwordx4 v[32:35], v1, s[24:27], s55 offen offset:512 nt
  v_perm_b32 v58, v12, v8, s58
  v_perm_b32 v62, v12, v8, s59
  v_perm_b32 v66, v13, v9, s58
  v_perm_b32 v70, v13, v9, s59
  v_perm_b32 v74, v14, v10, s58
  v_perm_b32 v78, v14, v10, s59
  v_perm_b32 v82, v15, v11, s58
  v_perm_b32 v86, v15, v11, s59
  s_waitcnt vmcnt(4)
  buffer_load_dwordx4 v[36:39], v1, s[24:27], s55 offen offset:768 nt
  v_mfma_f32_16x16x32_bf16 a[24:27], v[120:123], v[112:115], 0
  v_mfma_f32_16x16x32_bf16 a[28:31], v[120:123], v[116:119], 0
  s_add_u32 s68, s88, 8585216
  s_waitcnt vmcnt(4)
  v_perm_b32 v59, v20, v16, s58
  v_perm_b32 v63, v20, v16, s59
  v_perm_b32 v67, v21, v17, s58
  v_perm_b32 v71, v21, v17, s59
  v_perm_b32 v75, v22, v18, s58
  v_perm_b32 v79, v22, v18, s59
  v_perm_b32 v83, v23, v19, s58
  v_perm_b32 v87, v23, v19, s59
  s_waitcnt vmcnt(3)
  buffer_load_dwordx4 v[40:43], v1, s[24:27], s55 offen offset:1024 nt
  buffer_load_dwordx4 v[44:47], v1, s[24:27], s55 offen offset:1280 nt
  s_waitcnt lgkmcnt(0)
  v_mfma_f32_16x16x32_bf16 a[0:3], v[124:127], v[56:59], a[0:3]
  v_mfma_f32_16x16x32_bf16 a[4:7], v[124:127], v[60:63], a[4:7]
  s_waitcnt vmcnt(4)
  buffer_load_dwordx4 v[48:51], v1, s[24:27], s55 offen offset:1536 nt
  v_perm_b32 v88, v28, v24, s58
  v_perm_b32 v92, v28, v24, s59
  v_perm_b32 v96, v29, v25, s58
  v_perm_b32 v100, v29, v25, s59
  v_perm_b32 v104, v30, v26, s58
  v_perm_b32 v108, v30, v26, s59
  v_perm_b32 v112, v31, v27, s58
  v_perm_b32 v116, v31, v27, s59
  s_waitcnt vmcnt(4)
  buffer_load_dwordx4 v[52:55], v1, s[24:27], s55 offen offset:1792 nt
  v_mfma_f32_16x16x32_bf16 a[8:11], v[124:127], v[64:67], a[8:11]
  v_mfma_f32_16x16x32_bf16 a[12:15], v[124:127], v[68:71], a[12:15]
  s_waitcnt vmcnt(4)
  v_perm_b32 v89, v36, v32, s58
  v_perm_b32 v93, v36, v32, s59
  v_perm_b32 v97, v37, v33, s58
  v_perm_b32 v101, v37, v33, s59
  v_perm_b32 v105, v38, v34, s58
  v_perm_b32 v109, v38, v34, s59
  v_perm_b32 v113, v39, v35, s58
  v_perm_b32 v117, v39, v35, s59
  ds_read_b128 v[120:123], v5 offset:5120
  s_waitcnt vmcnt(3)
  buffer_load_dwordx4 v[8:11], v1, s[24:27], s68 offen offset:0 nt
  buffer_load_dwordx4 v[12:15], v1, s[24:27], s68 offen offset:256 nt
  v_mfma_f32_16x16x32_bf16 a[16:19], v[124:127], v[72:75], a[16:19]
  v_mfma_f32_16x16x32_bf16 a[20:23], v[124:127], v[76:79], a[20:23]
  s_waitcnt vmcnt(4)
  buffer_load_dwordx4 v[16:19], v1, s[24:27], s68 offen offset:512 nt
  v_perm_b32 v90, v44, v40, s58
  v_perm_b32 v94, v44, v40, s59
  v_perm_b32 v98, v45, v41, s58
  v_perm_b32 v102, v45, v41, s59
  v_perm_b32 v106, v46, v42, s58
  v_perm_b32 v110, v46, v42, s59
  v_perm_b32 v114, v47, v43, s58
  v_perm_b32 v118, v47, v43, s59
  s_waitcnt vmcnt(4)
  buffer_load_dwordx4 v[20:23], v1, s[24:27], s68 offen offset:768 nt
  v_mfma_f32_16x16x32_bf16 a[24:27], v[124:127], v[80:83], a[24:27]
  v_mfma_f32_16x16x32_bf16 a[28:31], v[124:127], v[84:87], a[28:31]
  s_add_u32 s55, s88, 8650752
  s_waitcnt vmcnt(4)
  v_perm_b32 v91, v52, v48, s58
  v_perm_b32 v95, v52, v48, s59
  v_perm_b32 v99, v53, v49, s58
  v_perm_b32 v103, v53, v49, s59
  v_perm_b32 v107, v54, v50, s58
  v_perm_b32 v111, v54, v50, s59
  v_perm_b32 v115, v55, v51, s58
  v_perm_b32 v119, v55, v51, s59
  s_waitcnt vmcnt(3)
  buffer_load_dwordx4 v[24:27], v1, s[24:27], s68 offen offset:1024 nt
  buffer_load_dwordx4 v[28:31], v1, s[24:27], s68 offen offset:1280 nt
  s_waitcnt lgkmcnt(0)
  v_mfma_f32_16x16x32_bf16 a[0:3], v[120:123], v[88:91], a[0:3]
  v_mfma_f32_16x16x32_bf16 a[4:7], v[120:123], v[92:95], a[4:7]
  s_waitcnt vmcnt(4)
  buffer_load_dwordx4 v[32:35], v1, s[24:27], s68 offen offset:1536 nt
  v_perm_b32 v56, v12, v8, s58
  v_perm_b32 v60, v12, v8, s59
  v_perm_b32 v64, v13, v9, s58
  v_perm_b32 v68, v13, v9, s59
  v_perm_b32 v72, v14, v10, s58
  v_perm_b32 v76, v14, v10, s59
  v_perm_b32 v80, v15, v11, s58
  v_perm_b32 v84, v15, v11, s59
  s_waitcnt vmcnt(4)
  buffer_load_dwordx4 v[36:39], v1, s[24:27], s68 offen offset:1792 nt
  v_mfma_f32_16x16x32_bf16 a[8:11], v[120:123], v[96:99], a[8:11]
  v_mfma_f32_16x16x32_bf16 a[12:15], v[120:123], v[100:103], a[12:15]
  s_waitcnt vmcnt(4)
  v_perm_b32 v57, v20, v16, s58
  v_perm_b32 v61, v20, v16, s59
  v_perm_b32 v65, v21, v17, s58
  v_perm_b32 v69, v21, v17, s59
  v_perm_b32 v73, v22, v18, s58
  v_perm_b32 v77, v22, v18, s59
  v_perm_b32 v81, v23, v19, s58
  v_perm_b32 v85, v23, v19, s59
  ds_read_b128 v[124:127], v5 offset:5632
  s_waitcnt vmcnt(3)
  buffer_load_dwordx4 v[40:43], v1, s[24:27], s55 offen offset:0 nt
  buffer_load_dwordx4 v[44:47], v1, s[24:27], s55 offen offset:256 nt
  v_mfma_f32_16x16x32_bf16 a[16:19], v[120:123], v[104:107], a[16:19]
  v_mfma_f32_16x16x32_bf16 a[20:23], v[120:123], v[108:111], a[20:23]
  s_waitcnt vmcnt(4)
  buffer_load_dwordx4 v[48:51], v1, s[24:27], s55 offen offset:512 nt
  v_perm_b32 v58, v28, v24, s58
  v_perm_b32 v62, v28, v24, s59
  v_perm_b32 v66, v29, v25, s58
  v_perm_b32 v70, v29, v25, s59
  v_perm_b32 v74, v30, v26, s58
  v_perm_b32 v78, v30, v26, s59
  v_perm_b32 v82, v31, v27, s58
  v_perm_b32 v86, v31, v27, s59
  s_waitcnt vmcnt(4)
  buffer_load_dwordx4 v[52:55], v1, s[24:27], s55 offen offset:768 nt
  v_mfma_f32_16x16x32_bf16 a[24:27], v[120:123], v[112:115], a[24:27]
  v_mfma_f32_16x16x32_bf16 a[28:31], v[120:123], v[116:119], a[28:31]
  s_add_u32 s68, s88, 8716288
  s_waitcnt vmcnt(4)
  v_perm_b32 v59, v36, v32, s58
  v_perm_b32 v63, v36, v32, s59
  v_perm_b32 v67, v37, v33, s58
  v_perm_b32 v71, v37, v33, s59
  v_perm_b32 v75, v38, v34, s58
  v_perm_b32 v79, v38, v34, s59
  v_perm_b32 v83, v39, v35, s58
  v_perm_b32 v87, v39, v35, s59
  s_waitcnt vmcnt(3)
  buffer_load_dwordx4 v[8:11], v1, s[24:27], s55 offen offset:1024 nt
  buffer_load_dwordx4 v[12:15], v1, s[24:27], s55 offen offset:1280 nt
  s_waitcnt lgkmcnt(0)
  v_mfma_f32_16x16x32_bf16 a[0:3], v[124:127], v[56:59], a[0:3]
  v_mfma_f32_16x16x32_bf16 a[4:7], v[124:127], v[60:63], a[4:7]
  s_waitcnt vmcnt(4)
  buffer_load_dwordx4 v[16:19], v1, s[24:27], s55 offen offset:1536 nt
  v_perm_b32 v88, v44, v40, s58
  v_perm_b32 v92, v44, v40, s59
  v_perm_b32 v96, v45, v41, s58
  v_perm_b32 v100, v45, v41, s59
  v_perm_b32 v104, v46, v42, s58
  v_perm_b32 v108, v46, v42, s59
  v_perm_b32 v112, v47, v43, s58
  v_perm_b32 v116, v47, v43, s59
  s_waitcnt vmcnt(4)
  buffer_load_dwordx4 v[20:23], v1, s[24:27], s55 offen offset:1792 nt
  v_mfma_f32_16x16x32_bf16 a[8:11], v[124:127], v[64:67], a[8:11]
  v_mfma_f32_16x16x32_bf16 a[12:15], v[124:127], v[68:71], a[12:15]
  s_waitcnt vmcnt(4)
  v_perm_b32 v89, v52, v48, s58
  v_perm_b32 v93, v52, v48, s59
  v_perm_b32 v97, v53, v49, s58
  v_perm_b32 v101, v53, v49, s59
  v_perm_b32 v105, v54, v50, s58
  v_perm_b32 v109, v54, v50, s59
  v_perm_b32 v113, v55, v51, s58
  v_perm_b32 v117, v55, v51, s59
  ds_read_b128 v[120:123], v5 offset:6144
  s_waitcnt vmcnt(3)
  buffer_load_dwordx4 v[24:27], v1, s[24:27], s68 offen offset:0 nt
  buffer_load_dwordx4 v[28:31], v1, s[24:27], s68 offen offset:256 nt
  v_mfma_f32_16x16x32_bf16 a[16:19], v[124:127], v[72:75], a[16:19]
  v_mfma_f32_16x16x32_bf16 a[20:23], v[124:127], v[76:79], a[20:23]
  s_waitcnt vmcnt(4)
  buffer_load_dwordx4 v[32:35], v1, s[24:27], s68 offen offset:512 nt
  v_perm_b32 v90, v12, v8, s58
  v_perm_b32 v94, v12, v8, s59
  v_perm_b32 v98, v13, v9, s58
  v_perm_b32 v102, v13, v9, s59
  v_perm_b32 v106, v14, v10, s58
  v_perm_b32 v110, v14, v10, s59
  v_perm_b32 v114, v15, v11, s58
  v_perm_b32 v118, v15, v11, s59
  s_waitcnt vmcnt(4)
  buffer_load_dwordx4 v[36:39], v1, s[24:27], s68 offen offset:768 nt
  v_mfma_f32_16x16x32_bf16 a[24:27], v[124:127], v[80:83], a[24:27]
  v_mfma_f32_16x16x32_bf16 a[28:31], v[124:127], v[84:87], a[28:31]
  s_add_u32 s55, s88, 8781824
  s_waitcnt vmcnt(4)
  v_perm_b32 v91, v20, v16, s58
  v_perm_b32 v95, v20, v16, s59
  v_perm_b32 v99, v21, v17, s58
  v_perm_b32 v103, v21, v17, s59
  v_perm_b32 v107, v22, v18, s58
  v_perm_b32 v111, v22, v18, s59
  v_perm_b32 v115, v23, v19, s58
  v_perm_b32 v119, v23, v19, s59
  s_waitcnt vmcnt(3)
  buffer_load_dwordx4 v[40:43], v1, s[24:27], s68 offen offset:1024 nt
  buffer_load_dwordx4 v[44:47], v1, s[24:27], s68 offen offset:1280 nt
  s_waitcnt lgkmcnt(0)
  v_mfma_f32_16x16x32_bf16 a[0:3], v[120:123], v[88:91], a[0:3]
  v_mfma_f32_16x16x32_bf16 a[4:7], v[120:123], v[92:95], a[4:7]
  s_waitcnt vmcnt(4)
  buffer_load_dwordx4 v[48:51], v1, s[24:27], s68 offen offset:1536 nt
  v_perm_b32 v56, v28, v24, s58
  v_perm_b32 v60, v28, v24, s59
  v_perm_b32 v64, v29, v25, s58
  v_perm_b32 v68, v29, v25, s59
  v_perm_b32 v72, v30, v26, s58
  v_perm_b32 v76, v30, v26, s59
  v_perm_b32 v80, v31, v27, s58
  v_perm_b32 v84, v31, v27, s59
  s_waitcnt vmcnt(4)
  buffer_load_dwordx4 v[52:55], v1, s[24:27], s68 offen offset:1792 nt
  v_mfma_f32_16x16x32_bf16 a[8:11], v[120:123], v[96:99], a[8:11]
  v_mfma_f32_16x16x32_bf16 a[12:15], v[120:123], v[100:103], a[12:15]
  s_waitcnt vmcnt(4)
  v_perm_b32 v57, v36, v32, s58
  v_perm_b32 v61, v36, v32, s59
  v_perm_b32 v65, v37, v33, s58
  v_perm_b32 v69, v37, v33, s59
  v_perm_b32 v73, v38, v34, s58
  v_perm_b32 v77, v38, v34, s59
  v_perm_b32 v81, v39, v35, s58
  v_perm_b32 v85, v39, v35, s59
  ds_read_b128 v[124:127], v5 offset:6656
  s_waitcnt vmcnt(3)
  buffer_load_dwordx4 v[8:11], v1, s[24:27], s55 offen offset:0 nt
  buffer_load_dwordx4 v[12:15], v1, s[24:27], s55 offen offset:256 nt
  v_mfma_f32_16x16x32_bf16 a[16:19], v[120:123], v[104:107], a[16:19]
  v_mfma_f32_16x16x32_bf16 a[20:23], v[120:123], v[108:111], a[20:23]
  s_waitcnt vmcnt(4)
  buffer_load_dwordx4 v[16:19], v1, s[24:27], s55 offen offset:512 nt
  v_perm_b32 v58, v44, v40, s58
  v_perm_b32 v62, v44, v40, s59
  v_perm_b32 v66, v45, v41, s58
  v_perm_b32 v70, v45, v41, s59
  v_perm_b32 v74, v46, v42, s58
  v_perm_b32 v78, v46, v42, s59
  v_perm_b32 v82, v47, v43, s58
  v_perm_b32 v86, v47, v43, s59
  s_waitcnt vmcnt(4)
  buffer_load_dwordx4 v[20:23], v1, s[24:27], s55 offen offset:768 nt
  v_mfma_f32_16x16x32_bf16 a[24:27], v[120:123], v[112:115], a[24:27]
  v_mfma_f32_16x16x32_bf16 a[28:31], v[120:123], v[116:119], a[28:31]
  s_add_u32 s68, s88, 8847360
  s_waitcnt vmcnt(4)
  v_perm_b32 v59, v52, v48, s58
  v_perm_b32 v63, v52, v48, s59
  v_perm_b32 v67, v53, v49, s58
  v_perm_b32 v71, v53, v49, s59
  v_perm_b32 v75, v54, v50, s58
  v_perm_b32 v79, v54, v50, s59
  v_perm_b32 v83, v55, v51, s58
  v_perm_b32 v87, v55, v51, s59
  s_waitcnt vmcnt(3)
  buffer_load_dwordx4 v[24:27], v1, s[24:27], s55 offen offset:1024 nt
  buffer_load_dwordx4 v[28:31], v1, s[24:27], s55 offen offset:1280 nt
  s_waitcnt lgkmcnt(0)
  v_mfma_f32_16x16x32_bf16 a[0:3], v[124:127], v[56:59], a[0:3]
  v_mfma_f32_16x16x32_bf16 a[4:7], v[124:127], v[60:63], a[4:7]
  s_waitcnt vmcnt(4)
  buffer_load_dwordx4 v[32:35], v1, s[24:27], s55 offen offset:1536 nt
  v_perm_b32 v88, v12, v8, s58
  v_perm_b32 v92, v12, v8, s59
  v_perm_b32 v96, v13, v9, s58
  v_perm_b32 v100, v13, v9, s59
  v_perm_b32 v104, v14, v10, s58
  v_perm_b32 v108, v14, v10, s59
  v_perm_b32 v112, v15, v11, s58
  v_perm_b32 v116, v15, v11, s59
  s_waitcnt vmcnt(4)
  buffer_load_dwordx4 v[36:39], v1, s[24:27], s55 offen offset:1792 nt
  v_mfma_f32_16x16x32_bf16 a[8:11], v[124:127], v[64:67], a[8:11]
  v_mfma_f32_16x16x32_bf16 a[12:15], v[124:127], v[68:71], a[12:15]
  s_waitcnt vmcnt(4)
  v_perm_b32 v89, v20, v16, s58
  v_perm_b32 v93, v20, v16, s59
  v_perm_b32 v97, v21, v17, s58
  v_perm_b32 v101, v21, v17, s59
  v_perm_b32 v105, v22, v18, s58
  v_perm_b32 v109, v22, v18, s59
  v_perm_b32 v113, v23, v19, s58
  v_perm_b32 v117, v23, v19, s59
  ds_read_b128 v[120:123], v5 offset:7168
  s_waitcnt vmcnt(3)
  buffer_load_dwordx4 v[40:43], v1, s[24:27], s68 offen offset:0 nt
  buffer_load_dwordx4 v[44:47], v1, s[24:27], s68 offen offset:256 nt
  v_mfma_f32_16x16x32_bf16 a[16:19], v[124:127], v[72:75], a[16:19]
  v_mfma_f32_16x16x32_bf16 a[20:23], v[124:127], v[76:79], a[20:23]
  s_waitcnt vmcnt(4)
  buffer_load_dwordx4 v[48:51], v1, s[24:27], s68 offen offset:512 nt
  v_perm_b32 v90, v28, v24, s58
  v_perm_b32 v94, v28, v24, s59
  v_perm_b32 v98, v29, v25, s58
  v_perm_b32 v102, v29, v25, s59
  v_perm_b32 v106, v30, v26, s58
  v_perm_b32 v110, v30, v26, s59
  v_perm_b32 v114, v31, v27, s58
  v_perm_b32 v118, v31, v27, s59
  s_waitcnt vmcnt(4)
  buffer_load_dwordx4 v[52:55], v1, s[24:27], s68 offen offset:768 nt
  v_mfma_f32_16x16x32_bf16 a[24:27], v[124:127], v[80:83], a[24:27]
  v_mfma_f32_16x16x32_bf16 a[28:31], v[124:127], v[84:87], a[28:31]
  s_add_u32 s55, s88, 12582912
  s_waitcnt vmcnt(4)
  v_perm_b32 v91, v36, v32, s58
  v_perm_b32 v95, v36, v32, s59
  v_perm_b32 v99, v37, v33, s58
  v_perm_b32 v103, v37, v33, s59
  v_perm_b32 v107, v38, v34, s58
  v_perm_b32 v111, v38, v34, s59
  v_perm_b32 v115, v39, v35, s58
  v_perm_b32 v119, v39, v35, s59
  s_waitcnt vmcnt(3)
  buffer_load_dwordx4 v[8:11], v1, s[24:27], s68 offen offset:1024 nt
  buffer_load_dwordx4 v[12:15], v1, s[24:27], s68 offen offset:1280 nt
  s_waitcnt lgkmcnt(0)
  v_mfma_f32_16x16x32_bf16 a[0:3], v[120:123], v[88:91], a[0:3]
  v_mfma_f32_16x16x32_bf16 a[4:7], v[120:123], v[92:95], a[4:7]
  s_waitcnt vmcnt(4)
  buffer_load_dwordx4 v[16:19], v1, s[24:27], s68 offen offset:1536 nt
  v_perm_b32 v56, v44, v40, s58
  v_perm_b32 v60, v44, v40, s59
  v_perm_b32 v64, v45, v41, s58
  v_perm_b32 v68, v45, v41, s59
  v_perm_b32 v72, v46, v42, s58
  v_perm_b32 v76, v46, v42, s59
  v_perm_b32 v80, v47, v43, s58
  v_perm_b32 v84, v47, v43, s59
  s_waitcnt vmcnt(4)
  buffer_load_dwordx4 v[20:23], v1, s[24:27], s68 offen offset:1792 nt
  v_mfma_f32_16x16x32_bf16 a[8:11], v[120:123], v[96:99], a[8:11]
  v_mfma_f32_16x16x32_bf16 a[12:15], v[120:123], v[100:103], a[12:15]
  s_waitcnt vmcnt(4)
  v_perm_b32 v57, v52, v48, s58
  v_perm_b32 v61, v52, v48, s59
  v_perm_b32 v65, v53, v49, s58
  v_perm_b32 v69, v53, v49, s59
  v_perm_b32 v73, v54, v50, s58
  v_perm_b32 v77, v54, v50, s59
  v_perm_b32 v81, v55, v51, s58
  v_perm_b32 v85, v55, v51, s59
  ds_read_b128 v[124:127], v5 offset:7680
  s_waitcnt vmcnt(3)
  buffer_load_dwordx4 v[24:27], v1, s[24:27], s55 offen offset:0 nt
  buffer_load_dwordx4 v[28:31], v1, s[24:27], s55 offen offset:256 nt
  v_mfma_f32_16x16x32_bf16 a[16:19], v[120:123], v[104:107], a[16:19]
  v_mfma_f32_16x16x32_bf16 a[20:23], v[120:123], v[108:111], a[20:23]
  s_waitcnt vmcnt(4)
  buffer_load_dwordx4 v[32:35], v1, s[24:27], s55 offen offset:512 nt
  v_perm_b32 v58, v12, v8, s58
  v_perm_b32 v62, v12, v8, s59
  v_perm_b32 v66, v13, v9, s58
  v_perm_b32 v70, v13, v9, s59
  v_perm_b32 v74, v14, v10, s58
  v_perm_b32 v78, v14, v10, s59
  v_perm_b32 v82, v15, v11, s58
  v_perm_b32 v86, v15, v11, s59
  s_waitcnt vmcnt(4)
  buffer_load_dwordx4 v[36:39], v1, s[24:27], s55 offen offset:768 nt
  v_mfma_f32_16x16x32_bf16 a[24:27], v[120:123], v[112:115], a[24:27]
  v_mfma_f32_16x16x32_bf16 a[28:31], v[120:123], v[116:119], a[28:31]
  s_add_u32 s68, s88, 12648448
  s_waitcnt vmcnt(4)
  v_perm_b32 v59, v20, v16, s58
  v_perm_b32 v63, v20, v16, s59
  v_perm_b32 v67, v21, v17, s58
  v_perm_b32 v71, v21, v17, s59
  v_perm_b32 v75, v22, v18, s58
  v_perm_b32 v79, v22, v18, s59
  v_perm_b32 v83, v23, v19, s58
  v_perm_b32 v87, v23, v19, s59
  s_waitcnt vmcnt(3)
  buffer_load_dwordx4 v[40:43], v1, s[24:27], s55 offen offset:1024 nt
  buffer_load_dwordx4 v[44:47], v1, s[24:27], s55 offen offset:1280 nt
  s_waitcnt lgkmcnt(0)
  v_mfma_f32_16x16x32_bf16 a[0:3], v[124:127], v[56:59], a[0:3]
  v_mfma_f32_16x16x32_bf16 a[4:7], v[124:127], v[60:63], a[4:7]
  s_waitcnt vmcnt(4)
  buffer_load_dwordx4 v[48:51], v1, s[24:27], s55 offen offset:1536 nt
  v_perm_b32 v88, v28, v24, s58
  v_perm_b32 v92, v28, v24, s59
  v_perm_b32 v96, v29, v25, s58
  v_perm_b32 v100, v29, v25, s59
  v_perm_b32 v104, v30, v26, s58
  v_perm_b32 v108, v30, v26, s59
  v_perm_b32 v112, v31, v27, s58
  v_perm_b32 v116, v31, v27, s59
  s_waitcnt vmcnt(4)
  buffer_load_dwordx4 v[52:55], v1, s[24:27], s55 offen offset:1792 nt
  v_mfma_f32_16x16x32_bf16 a[8:11], v[124:127], v[64:67], a[8:11]
  v_mfma_f32_16x16x32_bf16 a[12:15], v[124:127], v[68:71], a[12:15]
  s_waitcnt vmcnt(4)
  v_perm_b32 v89, v36, v32, s58
  v_perm_b32 v93, v36, v32, s59
  v_perm_b32 v97, v37, v33, s58
  v_perm_b32 v101, v37, v33, s59
  v_perm_b32 v105, v38, v34, s58
  v_perm_b32 v109, v38, v34, s59
  v_perm_b32 v113, v39, v35, s58
  v_perm_b32 v117, v39, v35, s59
  ds_read_b128 v[120:123], v5 offset:4096
  s_waitcnt vmcnt(3)
  buffer_load_dwordx4 v[8:11], v1, s[24:27], s68 offen offset:0 nt
  buffer_load_dwordx4 v[12:15], v1, s[24:27], s68 offen offset:256 nt
  v_mfma_f32_16x16x32_bf16 a[16:19], v[124:127], v[72:75], a[16:19]
  v_mfma_f32_16x16x32_bf16 a[20:23], v[124:127], v[76:79], a[20:23]
  s_waitcnt vmcnt(4)
  buffer_load_dwordx4 v[16:19], v1, s[24:27], s68 offen offset:512 nt
  v_perm_b32 v90, v44, v40, s58
  v_perm_b32 v94, v44, v40, s59
  v_perm_b32 v98, v45, v41, s58
  v_perm_b32 v102, v45, v41, s59
  v_perm_b32 v106, v46, v42, s58
  v_perm_b32 v110, v46, v42, s59
  v_perm_b32 v114, v47, v43, s58
  v_perm_b32 v118, v47, v43, s59
  s_waitcnt vmcnt(4)
  buffer_load_dwordx4 v[20:23], v1, s[24:27], s68 offen offset:768 nt
  v_mfma_f32_16x16x32_bf16 a[24:27], v[124:127], v[80:83], a[24:27]
  v_mfma_f32_16x16x32_bf16 a[28:31], v[124:127], v[84:87], a[28:31]
  s_add_u32 s55, s88, 12713984
  s_waitcnt vmcnt(4)
  v_perm_b32 v91, v52, v48, s58
  v_perm_b32 v95, v52, v48, s59
  v_perm_b32 v99, v53, v49, s58
  v_perm_b32 v103, v53, v49, s59
  v_perm_b32 v107, v54, v50, s58
  v_perm_b32 v111, v54, v50, s59
  v_perm_b32 v115, v55, v51, s58
  v_perm_b32 v119, v55, v51, s59
  s_mov_b64 exec, 0xffff
  ds_write_b32 v4, a0 offset:4096
  ds_write_b32 v4, a4 offset:4100
  ds_write_b32 v4, a8 offset:4104
  ds_write_b32 v4, a12 offset:4108
  ds_write_b32 v4, a16 offset:4112
  ds_write_b32 v4, a20 offset:4116
  ds_write_b32 v4, a24 offset:4120
  ds_write_b32 v4, a28 offset:4124
  s_mov_b64 exec, -1
  s_waitcnt vmcnt(3)
  buffer_load_dwordx4 v[24:27], v1, s[24:27], s68 offen offset:1024 nt
  buffer_load_dwordx4 v[28:31], v1, s[24:27], s68 offen offset:1280 nt
  s_waitcnt lgkmcnt(0)
  v_mfma_f32_16x16x32_bf16 a[0:3], v[120:123], v[88:91], 0
  v_mfma_f32_16x16x32_bf16 a[4:7], v[120:123], v[92:95], 0
  s_waitcnt vmcnt(4)
  buffer_load_dwordx4 v[32:35], v1, s[24:27], s68 offen offset:1536 nt
  v_perm_b32 v56, v12, v8, s58
  v_perm_b32 v60, v12, v8, s59
  v_perm_b32 v64, v13, v9, s58
  v_perm_b32 v68, v13, v9, s59
  v_perm_b32 v72, v14, v10, s58
  v_perm_b32 v76, v14, v10, s59
  v_perm_b32 v80, v15, v11, s58
  v_perm_b32 v84, v15, v11, s59
  s_waitcnt vmcnt(4)
  buffer_load_dwordx4 v[36:39], v1, s[24:27], s68 offen offset:1792 nt
  v_mfma_f32_16x16x32_bf16 a[8:11], v[120:123], v[96:99], 0
  v_mfma_f32_16x16x32_bf16 a[12:15], v[120:123], v[100:103], 0
  s_waitcnt vmcnt(4)
  v_perm_b32 v57, v20, v16, s58
  v_perm_b32 v61, v20, v16, s59
  v_perm_b32 v65, v21, v17, s58
  v_perm_b32 v69, v21, v17, s59
  v_perm_b32 v73, v22, v18, s58
  v_perm_b32 v77, v22, v18, s59
  v_perm_b32 v81, v23, v19, s58
  v_perm_b32 v85, v23, v19, s59
  ds_read_b128 v[124:127], v5 offset:4608
  s_waitcnt vmcnt(3)
  buffer_load_dwordx4 v[40:43], v1, s[24:27], s55 offen offset:0 nt
  buffer_load_dwordx4 v[44:47], v1, s[24:27], s55 offen offset:256 nt
  v_mfma_f32_16x16x32_bf16 a[16:19], v[120:123], v[104:107], 0
  v_mfma_f32_16x16x32_bf16 a[20:23], v[120:123], v[108:111], 0
  s_waitcnt vmcnt(4)
  buffer_load_dwordx4 v[48:51], v1, s[24:27], s55 offen offset:512 nt
  v_perm_b32 v58, v28, v24, s58
  v_perm_b32 v62, v28, v24, s59
  v_perm_b32 v66, v29, v25, s58
  v_perm_b32 v70, v29, v25, s59
  v_perm_b32 v74, v30, v26, s58
  v_perm_b32 v78, v30, v26, s59
  v_perm_b32 v82, v31, v27, s58
  v_perm_b32 v86, v31, v27, s59
  s_waitcnt vmcnt(4)
  buffer_load_dwordx4 v[52:55], v1, s[24:27], s55 offen offset:768 nt
  v_mfma_f32_16x16x32_bf16 a[24:27], v[120:123], v[112:115], 0
  v_mfma_f32_16x16x32_bf16 a[28:31], v[120:123], v[116:119], 0
  s_add_u32 s68, s88, 12779520
  s_waitcnt vmcnt(4)
  v_perm_b32 v59, v36, v32, s58
  v_perm_b32 v63, v36, v32, s59
  v_perm_b32 v67, v37, v33, s58
  v_perm_b32 v71, v37, v33, s59
  v_perm_b32 v75, v38, v34, s58
  v_perm_b32 v79, v38, v34, s59
  v_perm_b32 v83, v39, v35, s58
  v_perm_b32 v87, v39, v35, s59
  s_waitcnt vmcnt(3)
  buffer_load_dwordx4 v[8:11], v1, s[24:27], s55 offen offset:1024 nt
  buffer_load_dwordx4 v[12:15], v1, s[24:27], s55 offen offset:1280 nt
  s_waitcnt lgkmcnt(0)
  v_mfma_f32_16x16x32_bf16 a[0:3], v[124:127], v[56:59], a[0:3]
  v_mfma_f32_16x16x32_bf16 a[4:7], v[124:127], v[60:63], a[4:7]
  s_waitcnt vmcnt(4)
  buffer_load_dwordx4 v[16:19], v1, s[24:27], s55 offen offset:1536 nt
  v_perm_b32 v88, v44, v40, s58
  v_perm_b32 v92, v44, v40, s59
  v_perm_b32 v96, v45, v41, s58
  v_perm_b32 v100, v45, v41, s59
  v_perm_b32 v104, v46, v42, s58
  v_perm_b32 v108, v46, v42, s59
  v_perm_b32 v112, v47, v43, s58
  v_perm_b32 v116, v47, v43, s59
  s_waitcnt vmcnt(4)
  buffer_load_dwordx4 v[20:23], v1, s[24:27], s55 offen offset:1792 nt
  v_mfma_f32_16x16x32_bf16 a[8:11], v[124:127], v[64:67], a[8:11]
  v_mfma_f32_16x16x32_bf16 a[12:15], v[124:127], v[68:71], a[12:15]
  s_waitcnt vmcnt(4)
  v_perm_b32 v89, v52, v48, s58
  v_perm_b32 v93, v52, v48, s59
  v_perm_b32 v97, v53, v49, s58
  v_perm_b32 v101, v53, v49, s59
  v_perm_b32 v105, v54, v50, s58
  v_perm_b32 v109, v54, v50, s59
  v_perm_b32 v113, v55, v51, s58
  v_perm_b32 v117, v55, v51, s59
  ds_read_b128 v[120:123], v5 offset:5120
  s_waitcnt vmcnt(3)
  buffer_load_dwordx4 v[24:27], v1, s[24:27], s68 offen offset:0 nt
  buffer_load_dwordx4 v[28:31], v1, s[24:27], s68 offen offset:256 nt
  v_mfma_f32_16x16x32_bf16 a[16:19], v[124:127], v[72:75], a[16:19]
  v_mfma_f32_16x16x32_bf16 a[20:23], v[124:127], v[76:79], a[20:23]
  s_waitcnt vmcnt(4)
  buffer_load_dwordx4 v[32:35], v1, s[24:27], s68 offen offset:512 nt
  v_perm_b32 v90, v12, v8, s58
  v_perm_b32 v94, v12, v8, s59
  v_perm_b32 v98, v13, v9, s58
  v_perm_b32 v102, v13, v9, s59
  v_perm_b32 v106, v14, v10, s58
  v_perm_b32 v110, v14, v10, s59
  v_perm_b32 v114, v15, v11, s58
  v_perm_b32 v118, v15, v11, s59
  s_waitcnt vmcnt(4)
  buffer_load_dwordx4 v[36:39], v1, s[24:27], s68 offen offset:768 nt
  v_mfma_f32_16x16x32_bf16 a[24:27], v[124:127], v[80:83], a[24:27]
  v_mfma_f32_16x16x32_bf16 a[28:31], v[124:127], v[84:87], a[28:31]
  s_add_u32 s55, s88, 12845056
  s_waitcnt vmcnt(4)
  v_perm_b32 v91, v20, v16, s58
  v_perm_b32 v95, v20, v16, s59
  v_perm_b32 v99, v21, v17, s58
  v_perm_b32 v103, v21, v17, s59
  v_perm_b32 v107, v22, v18, s58
  v_perm_b32 v111, v22, v18, s59
  v_perm_b32 v115, v23, v19, s58
  v_perm_b32 v119, v23, v19, s59
  s_waitcnt vmcnt(3)
  buffer_load_dwordx4 v[40:43], v1, s[24:27], s68 offen offset:1024 nt
  buffer_load_dwordx4 v[44:47], v1, s[24:27], s68 offen offset:1280 nt
  s_waitcnt lgkmcnt(0)
  v_mfma_f32_16x16x32_bf16 a[0:3], v[120:123], v[88:91], a[0:3]
  v_mfma_f32_16x16x32_bf16 a[4:7], v[120:123], v[92:95], a[4:7]
  s_waitcnt vmcnt(4)
  buffer_load_dwordx4 v[48:51], v1, s[24:27], s68 offen offset:1536 nt
  v_perm_b32 v56, v28, v24, s58
  v_perm_b32 v60, v28, v24, s59
  v_perm_b32 v64, v29, v25, s58
  v_perm_b32 v68, v29, v25, s59
  v_perm_b32 v72, v30, v26, s58
  v_perm_b32 v76, v30, v26, s59
  v_perm_b32 v80, v31, v27, s58
  v_perm_b32 v84, v31, v27, s59
  s_waitcnt vmcnt(4)
  buffer_load_dwordx4 v[52:55], v1, s[24:27], s68 offen offset:1792 nt
  v_mfma_f32_16x16x32_bf16 a[8:11], v[120:123], v[96:99], a[8:11]
  v_mfma_f32_16x16x32_bf16 a[12:15], v[120:123], v[100:103], a[12:15]
  s_waitcnt vmcnt(4)
  v_perm_b32 v57, v36, v32, s58
  v_perm_b32 v61, v36, v32, s59
  v_perm_b32 v65, v37, v33, s58
  v_perm_b32 v69, v37, v33, s59
  v_perm_b32 v73, v38, v34, s58
  v_perm_b32 v77, v38, v34, s59
  v_perm_b32 v81, v39, v35, s58
  v_perm_b32 v85, v39, v35, s59
  ds_read_b128 v[124:127], v5 offset:5632
  s_waitcnt vmcnt(3)
  buffer_load_dwordx4 v[8:11], v1, s[24:27], s55 offen offset:0 nt
  buffer_load_dwordx4 v[12:15], v1, s[24:27], s55 offen offset:256 nt
  v_mfma_f32_16x16x32_bf16 a[16:19], v[120:123], v[104:107], a[16:19]
  v_mfma_f32_16x16x32_bf16 a[20:23], v[120:123], v[108:111], a[20:23]
  s_waitcnt vmcnt(4)
  buffer_load_dwordx4 v[16:19], v1, s[24:27], s55 offen offset:512 nt
  v_perm_b32 v58, v44, v40, s58
  v_perm_b32 v62, v44, v40, s59
  v_perm_b32 v66, v45, v41, s58
  v_perm_b32 v70, v45, v41, s59
  v_perm_b32 v74, v46, v42, s58
  v_perm_b32 v78, v46, v42, s59
  v_perm_b32 v82, v47, v43, s58
  v_perm_b32 v86, v47, v43, s59
  s_waitcnt vmcnt(4)
  buffer_load_dwordx4 v[20:23], v1, s[24:27], s55 offen offset:768 nt
  v_mfma_f32_16x16x32_bf16 a[24:27], v[120:123], v[112:115], a[24:27]
  v_mfma_f32_16x16x32_bf16 a[28:31], v[120:123], v[116:119], a[28:31]
  s_add_u32 s68, s88, 12910592
  s_waitcnt vmcnt(4)
  v_perm_b32 v59, v52, v48, s58
  v_perm_b32 v63, v52, v48, s59
  v_perm_b32 v67, v53, v49, s58
  v_perm_b32 v71, v53, v49, s59
  v_perm_b32 v75, v54, v50, s58
  v_perm_b32 v79, v54, v50, s59
  v_perm_b32 v83, v55, v51, s58
  v_perm_b32 v87, v55, v51, s59
  s_waitcnt vmcnt(3)
  buffer_load_dwordx4 v[24:27], v1, s[24:27], s55 offen offset:1024 nt
  buffer_load_dwordx4 v[28:31], v1, s[24:27], s55 offen offset:1280 nt
  buffer_load_dwordx4 v[32:35], v1, s[24:27], s55 offen offset:1536 nt
  buffer_load_dwordx4 v[36:39], v1, s[24:27], s55 offen offset:1792 nt
  buffer_load_dwordx4 v[40:43], v1, s[24:27], s68 offen offset:0 nt
  buffer_load_dwordx4 v[44:47], v1, s[24:27], s68 offen offset:256 nt
  buffer_load_dwordx4 v[48:51], v1, s[24:27], s68 offen offset:512 nt
  s_waitcnt lgkmcnt(0)
  v_mfma_f32_16x16x32_bf16 a[0:3], v[124:127], v[56:59], a[0:3]
  v_mfma_f32_16x16x32_bf16 a[4:7], v[124:127], v[60:63], a[4:7]
  s_waitcnt vmcnt(9)
  buffer_load_dwordx4 v[52:55], v1, s[24:27], s68 offen offset:768 nt
  v_perm_b32 v88, v12, v8, s58
  v_perm_b32 v92, v12, v8, s59
  v_perm_b32 v96, v13, v9, s58
  v_perm_b32 v100, v13, v9, s59
  v_perm_b32 v104, v14, v10, s58
  v_perm_b32 v108, v14, v10, s59
  v_perm_b32 v112, v15, v11, s58
  v_perm_b32 v116, v15, v11, s59
  s_add_u32 s55, s88, 12976128
  s_waitcnt vmcnt(9)
  buffer_load_dwordx4 v[8:11], v1, s[24:27], s68 offen offset:1024 nt
  v_mfma_f32_16x16x32_bf16 a[8:11], v[124:127], v[64:67], a[8:11]
  v_mfma_f32_16x16x32_bf16 a[12:15], v[124:127], v[68:71], a[12:15]
  s_waitcnt vmcnt(9)
  buffer_load_dwordx4 v[12:15], v1, s[24:27], s68 offen offset:1280 nt
  v_perm_b32 v89, v20, v16, s58
  v_perm_b32 v93, v20, v16, s59
  v_perm_b32 v97, v21, v17, s58
  v_perm_b32 v101, v21, v17, s59
  v_perm_b32 v105, v22, v18, s58
  v_perm_b32 v109, v22, v18, s59
  v_perm_b32 v113, v23, v19, s58
  v_perm_b32 v117, v23, v19, s59
  ds_read_b128 v[120:123], v5 offset:6144
  s_waitcnt vmcnt(9)
  buffer_load_dwordx4 v[16:19], v1, s[24:27], s68 offen offset:1536 nt
  v_mfma_f32_16x16x32_bf16 a[16:19], v[124:127], v[72:75], a[16:19]
  v_mfma_f32_16x16x32_bf16 a[20:23], v[124:127], v[76:79], a[20:23]
  s_waitcnt vmcnt(9)
  buffer_load_dwordx4 v[20:23], v1, s[24:27], s68 offen offset:1792 nt
  v_perm_b32 v90, v28, v24, s58
  v_perm_b32 v94, v28, v24, s59
  v_perm_b32 v98, v29, v25, s58
  v_perm_b32 v102, v29, v25, s59
  v_perm_b32 v106, v30, v26, s58
  v_perm_b32 v110, v30, v26, s59
  v_perm_b32 v114, v31, v27, s58
  v_perm_b32 v118, v31, v27, s59
  s_waitcnt vmcnt(9)
  buffer_load_dwordx4 v[24:27], v1, s[24:27], s55 offen offset:0 nt
  v_mfma_f32_16x16x32_bf16 a[24:27], v[124:127], v[80:83], a[24:27]
  v_mfma_f32_16x16x32_bf16 a[28:31], v[124:127], v[84:87], a[28:31]
  s_waitcnt vmcnt(9)
  buffer_load_dwordx4 v[28:31], v1, s[24:27], s55 offen offset:256 nt
  v_perm_b32 v91, v36, v32, s58
  v_perm_b32 v95, v36, v32, s59
  v_perm_b32 v99, v37, v33, s58
  v_perm_b32 v103, v37, v33, s59
  v_perm_b32 v107, v38, v34, s58
  v_perm_b32 v111, v38, v34, s59
  v_perm_b32 v115, v39, v35, s58
  v_perm_b32 v119, v39, v35, s59
  s_waitcnt vmcnt(9)
  buffer_load_dwordx4 v[32:35], v1, s[24:27], s55 offen offset:512 nt
  s_waitcnt lgkmcnt(0)
  v_mfma_f32_16x16x32_bf16 a[0:3], v[120:123], v[88:91], a[0:3]
  v_mfma_f32_16x16x32_bf16 a[4:7], v[120:123], v[92:95], a[4:7]
  s_waitcnt vmcnt(9)
  buffer_load_dwordx4 v[36:39], v1, s[24:27], s55 offen offset:768 nt
  v_perm_b32 v56, v44, v40, s58
  v_perm_b32 v60, v44, v40, s59
  v_perm_b32 v64, v45, v41, s58
  v_perm_b32 v68, v45, v41, s59
  v_perm_b32 v72, v46, v42, s58
  v_perm_b32 v76, v46, v42, s59
  v_perm_b32 v80, v47, v43, s58
  v_perm_b32 v84, v47, v43, s59
  s_add_u32 s68, s88, 13041664
  s_waitcnt vmcnt(9)
  buffer_load_dwordx4 v[40:43], v1, s[24:27], s55 offen offset:1024 nt
  v_mfma_f32_16x16x32_bf16 a[8:11], v[120:123], v[96:99], a[8:11]
  v_mfma_f32_16x16x32_bf16 a[12:15], v[120:123], v[100:103], a[12:15]
  s_waitcnt vmcnt(9)
  buffer_load_dwordx4 v[44:47], v1, s[24:27], s55 offen offset:1280 nt
  v_perm_b32 v57, v52, v48, s58
  v_perm_b32 v61, v52, v48, s59
  v_perm_b32 v65, v53, v49, s58
  v_perm_b32 v69, v53, v49, s59
  v_perm_b32 v73, v54, v50, s58
  v_perm_b32 v77, v54, v50, s59
  v_perm_b32 v81, v55, v51, s58
  v_perm_b32 v85, v55, v51, s59
  ds_read_b128 v[124:127], v5 offset:6656
  s_waitcnt vmcnt(9)
  buffer_load_dwordx4 v[48:51], v1, s[24:27], s55 offen offset:1536 nt
  v_mfma_f32_16x16x32_bf16 a[16:19], v[120:123], v[104:107], a[16:19]
  v_mfma_f32_16x16x32_bf16 a[20:23], v[120:123], v[108:111], a[20:23]
  s_waitcnt vmcnt(9)
  buffer_load_dwordx4 v[52:55], v1, s[24:27], s55 offen offset:1792 nt
  v_perm_b32 v58, v12, v8, s58
  v_perm_b32 v62, v12, v8, s59
  v_perm_b32 v66, v13, v9, s58
  v_perm_b32 v70, v13, v9, s59
  v_perm_b32 v74, v14, v10, s58
  v_perm_b32 v78, v14, v10, s59
  v_perm_b32 v82, v15, v11, s58
  v_perm_b32 v86, v15, v11, s59
  s_waitcnt vmcnt(9)
  buffer_load_dwordx4 v[8:11], v1, s[24:27], s68 offen offset:0 nt
  v_mfma_f32_16x16x32_bf16 a[24:27], v[120:123], v[112:115], a[24:27]
  v_mfma_f32_16x16x32_bf16 a[28:31], v[120:123], v[116:119], a[28:31]
  s_waitcnt vmcnt(9)
  buffer_load_dwordx4 v[12:15], v1, s[24:27], s68 offen offset:256 nt
  v_perm_b32 v59, v20, v16, s58
  v_perm_b32 v63, v20, v16, s59
  v_perm_b32 v67, v21, v17, s58
  v_perm_b32 v71, v21, v17, s59
  v_perm_b32 v75, v22, v18, s58
  v_perm_b32 v79, v22, v18, s59
  v_perm_b32 v83, v23, v19, s58
  v_perm_b32 v87, v23, v19, s59
  s_waitcnt vmcnt(9)
  buffer_load_dwordx4 v[16:19], v1, s[24:27], s68 offen offset:512 nt
  s_waitcnt lgkmcnt(0)
  v_mfma_f32_16x16x32_bf16 a[0:3], v[124:127], v[56:59], a[0:3]
  v_mfma_f32_16x16x32_bf16 a[4:7], v[124:127], v[60:63], a[4:7]
  s_waitcnt vmcnt(9)
  buffer_load_dwordx4 v[20:23], v1, s[24:27], s68 offen offset:768 nt
  v_perm_b32 v88, v28, v24, s58
  v_perm_b32 v92, v28, v24, s59
  v_perm_b32 v96, v29, v25, s58
  v_perm_b32 v100, v29, v25, s59
  v_perm_b32 v104, v30, v26, s58
  v_perm_b32 v108, v30, v26, s59
  v_perm_b32 v112, v31, v27, s58
  v_perm_b32 v116, v31, v27, s59
  s_waitcnt vmcnt(9)
  buffer_load_dwordx4 v[24:27], v1, s[24:27], s68 offen offset:1024 nt
  v_mfma_f32_16x16x32_bf16 a[8:11], v[124:127], v[64:67], a[8:11]
  v_mfma_f32_16x16x32_bf16 a[12:15], v[124:127], v[68:71], a[12:15]
  s_waitcnt vmcnt(9)
  buffer_load_dwordx4 v[28:31], v1, s[24:27], s68 offen offset:1280 nt
  v_perm_b32 v89, v36, v32, s58
  v_perm_b32 v93, v36, v32, s59
  v_perm_b32 v97, v37, v33, s58
  v_perm_b32 v101, v37, v33, s59
  v_perm_b32 v105, v38, v34, s58
  v_perm_b32 v109, v38, v34, s59
  v_perm_b32 v113, v39, v35, s58
  v_perm_b32 v117, v39, v35, s59
  ds_read_b128 v[120:123], v5 offset:7168
  s_waitcnt vmcnt(9)
  buffer_load_dwordx4 v[32:35], v1, s[24:27], s68 offen offset:1536 nt
  v_mfma_f32_16x16x32_bf16 a[16:19], v[124:127], v[72:75], a[16:19]
  v_mfma_f32_16x16x32_bf16 a[20:23], v[124:127], v[76:79], a[20:23]
  s_waitcnt vmcnt(9)
  buffer_load_dwordx4 v[36:39], v1, s[24:27], s68 offen offset:1792 nt
  v_perm_b32 v90, v44, v40, s58
  v_perm_b32 v94, v44, v40, s59
  v_perm_b32 v98, v45, v41, s58
  v_perm_b32 v102, v45, v41, s59
  v_perm_b32 v106, v46, v42, s58
  v_perm_b32 v110, v46, v42, s59
  v_perm_b32 v114, v47, v43, s58
  v_perm_b32 v118, v47, v43, s59
  s_waitcnt vmcnt(9)
  v_mfma_f32_16x16x32_bf16 a[24:27], v[124:127], v[80:83], a[24:27]
  v_mfma_f32_16x16x32_bf16 a[28:31], v[124:127], v[84:87], a[28:31]
  s_waitcnt vmcnt(8)
  v_perm_b32 v91, v52, v48, s58
  v_perm_b32 v95, v52, v48, s59
  v_perm_b32 v99, v53, v49, s58
  v_perm_b32 v103, v53, v49, s59
  v_perm_b32 v107, v54, v50, s58
  v_perm_b32 v111, v54, v50, s59
  v_perm_b32 v115, v55, v51, s58
  v_perm_b32 v119, v55, v51, s59
  s_waitcnt vmcnt(7)
  s_waitcnt lgkmcnt(0)
  v_mfma_f32_16x16x32_bf16 a[0:3], v[120:123], v[88:91], a[0:3]
  v_mfma_f32_16x16x32_bf16 a[4:7], v[120:123], v[92:95], a[4:7]
  s_waitcnt vmcnt(6)
  v_perm_b32 v56, v12, v8, s58
  v_perm_b32 v60, v12, v8, s59
  v_perm_b32 v64, v13, v9, s58
  v_perm_b32 v68, v13, v9, s59
  v_perm_b32 v72, v14, v10, s58
  v_perm_b32 v76, v14, v10, s59
  v_perm_b32 v80, v15, v11, s58
  v_perm_b32 v84, v15, v11, s59
  s_waitcnt vmcnt(5)
  v_mfma_f32_16x16x32_bf16 a[8:11], v[120:123], v[96:99], a[8:11]
  v_mfma_f32_16x16x32_bf16 a[12:15], v[120:123], v[100:103], a[12:15]
  s_waitcnt vmcnt(4)
  v_perm_b32 v57, v20, v16, s58
  v_perm_b32 v61, v20, v16, s59
  v_perm_b32 v65, v21, v17, s58
  v_perm_b32 v69, v21, v17, s59
  v_perm_b32 v73, v22, v18, s58
  v_perm_b32 v77, v22, v18, s59
  v_perm_b32 v81, v23, v19, s58
  v_perm_b32 v85, v23, v19, s59
  ds_read_b128 v[124:127], v5 offset:7680
  s_waitcnt vmcnt(3)
  v_mfma_f32_16x16x32_bf16 a[16:19], v[120:123], v[104:107], a[16:19]
  v_mfma_f32_16x16x32_bf16 a[20:23], v[120:123], v[108:111], a[20:23]
  s_waitcnt vmcnt(2)
  v_perm_b32 v58, v28, v24, s58
  v_perm_b32 v62, v28, v24, s59
  v_perm_b32 v66, v29, v25, s58
  v_perm_b32 v70, v29, v25, s59
  v_perm_b32 v74, v30, v26, s58
  v_perm_b32 v78, v30, v26, s59
  v_perm_b32 v82, v31, v27, s58
  v_perm_b32 v86, v31, v27, s59
  s_waitcnt vmcnt(1)
  s_waitcnt lgkmcnt(0)
  v_mfma_f32_16x16x32_bf16 a[24:27], v[120:123], v[112:115], a[24:27]
  v_mfma_f32_16x16x32_bf16 a[28:31], v[120:123], v[116:119], a[28:31]
  s_waitcnt vmcnt(0)
  v_perm_b32 v59, v36, v32, s58
  v_perm_b32 v63, v36, v32, s59
  v_perm_b32 v67, v37, v33, s58
  v_perm_b32 v71, v37, v33, s59
  v_perm_b32 v75, v38, v34, s58
  v_perm_b32 v79, v38, v34, s59
  v_perm_b32 v83, v39, v35, s58
  v_perm_b32 v87, v39, v35, s59
  v_mfma_f32_16x16x32_bf16 a[0:3], v[124:127], v[56:59], a[0:3]
  v_mfma_f32_16x16x32_bf16 a[4:7], v[124:127], v[60:63], a[4:7]
  v_mfma_f32_16x16x32_bf16 a[8:11], v[124:127], v[64:67], a[8:11]
  v_mfma_f32_16x16x32_bf16 a[12:15], v[124:127], v[68:71], a[12:15]
  v_mfma_f32_16x16x32_bf16 a[16:19], v[124:127], v[72:75], a[16:19]
  v_mfma_f32_16x16x32_bf16 a[20:23], v[124:127], v[76:79], a[20:23]
  v_mfma_f32_16x16x32_bf16 a[24:27], v[124:127], v[80:83], a[24:27]
  v_mfma_f32_16x16x32_bf16 a[28:31], v[124:127], v[84:87], a[28:31]
  s_mov_b64 exec, 0xffff
  ds_write_b32 v4, a1 offset:6144
  ds_write_b32 v4, a5 offset:6148
  ds_write_b32 v4, a9 offset:6152
  ds_write_b32 v4, a13 offset:6156
  ds_write_b32 v4, a17 offset:6160
  ds_write_b32 v4, a21 offset:6164
  ds_write_b32 v4, a25 offset:6168
  ds_write_b32 v4, a29 offset:6172
  s_mov_b64 exec, -1
  s_waitcnt lgkmcnt(0)
  s_barrier
  s_endpgm
L_helper:
  s_mov_b32 s44, s16
  s_mov_b32 s45, s17
  s_mov_b32 s46, 256
  s_mov_b32 s47, 0x00020000
  s_lshl_b32 s56, s3, 3
  s_or_b32 s56, s56, s53
  s_cmp_lt_u32 s56, 3
  s_cbranch_scc0 L_voted
  s_waitcnt lgkmcnt(0)
  s_sub_u32 s92, s92, 3
  s_cmp_lt_u32 s92, 11
  s_cselect_b32 s56, 0, 1
  s_xor_b32 s56, s56, s98
  s_cmp_lt_u32 s53, 2
  s_cselect_b32 s57, s52, 0
  s_xor_b32 s56, s56, s57
  s_and_b32 s56, s56, 1
  s_lshl_b32 s57, s53, 3
  s_add_u32 s57, s57, 8
  s_lshl_b32 s56, s56, s57
  s_add_u32 s56, s56, 1
  v_mov_b32 v80, s56
  s_mov_b64 exec, 1
  buffer_atomic_add v80, off, s[44:47], 0 sc1
  s_mov_b64 exec, -1
L_voted:
  s_waitcnt vmcnt(0)
  s_mov_b32 s32, s12
  s_mov_b32 s33, s13
  s_mov_b32 s34, 1048576
  s_mov_b32 s35, 0x00020000
  s_lshl_b32 s56, s2, 12
  s_lshl_b32 s57, s3, 10
  s_add_u32 s56, s56, s57
  v_lshlrev_b32 v76, 4, v0
  buffer_load_dwordx4 v[88:91], v76, s[28:31], s56 offen
  buffer_load_dwordx4 v[92:95], v76, s[32:35], s56 offen
  s_add_u32 m0, s62, 0
  s_add_u32 s56, s55, 0
  buffer_load_dwordx4 v4, s[28:31], s56 offen  lds
  s_add_u32 m0, s62, 1024
  s_add_u32 s56, s55, 32768
  buffer_load_dwordx4 v5, s[28:31], s56 offen  lds
  s_add_u32 m0, s62, 2048
  s_add_u32 s56, s55, 65536
  buffer_load_dwordx4 v6, s[28:31], s56 offen  lds
  s_add_u32 m0, s62, 3072
  s_add_u32 s56, s55, 98304
  buffer_load_dwordx4 v7, s[28:31], s56 offen  lds
  s_add_u32 m0, s62, 4096
  s_add_u32 s56, s55, 131072
  buffer_load_dwordx4 v8, s[28:31], s56 offen  lds
  s_add_u32 m0, s62, 5120
  s_add_u32 s56, s55, 163840
  buffer_load_dwordx4 v9, s[28:31], s56 offen  lds
  s_add_u32 m0, s62, 6144
  s_add_u32 s56, s55, 196608
  buffer_load_dwordx4 v10, s[28:31], s56 offen  lds
  s_add_u32 m0, s62, 7168
  s_add_u32 s56, s55, 229376
  buffer_load_dwordx4 v11, s[28:31], s56 offen  lds
  v_lshrrev_b32 v69, 5, v0
  v_xor_b32 v68, v126, v69
  v_and_b32 v70, 1, v68
  v_lshlrev_b32 v70, 4, v70
  v_bfe_u32 v71, v68, 1, 1
  v_lshl_add_u32 v70, v71, 5, v70
  v_lshrrev_b32 v68, 2, v68
  v_lshl_add_u32 v70, v68, 7, v70
  v_and_b32 v68, 1, v127
  v_lshl_add_u32 v70, v68, 9, v70
  v_lshl_add_u32 v4, v69, 14, v70
  v_xor_b32 v5, 32, v4
  v_xor_b32 v6, 128, v4
  v_xor_b32 v7, 160, v4
  v_xor_b32 v8, 256, v4
  v_xor_b32 v9, 288, v4
  v_xor_b32 v10, 384, v4
  v_xor_b32 v11, 416, v4
  s_mov_b32 s32, s12
  s_mov_b32 s33, s13
  s_mov_b32 s34, 1048576
  s_mov_b32 s35, 0x00020000
  s_mov_b32 s40, s14
  s_mov_b32 s41, s15
  s_mov_b32 s42, 32768
  s_mov_b32 s43, 0x00020000
  s_mov_b32 s48, s18
  s_mov_b32 s49, s19
  s_mov_b32 s50, 1073741824
  s_mov_b32 s51, 0x00020000
  s_mov_b32 s60, 0x3e0293ee
  s_lshl_b32 s63, s52, 11
  s_lshl_b32 s65, s52, 14
  s_add_u32 s65, s65, 262144
  s_lshl_b32 s56, s3, 12
  s_add_u32 s64, s65, s56
  s_lshl_b32 s56, s53, 8
  s_add_u32 s64, s64, s56
  s_lshl_b32 s56, s53, 11
  s_add_u32 s65, s65, s56
  s_and_b32 s56, s53, 6
  s_add_u32 s66, s89, s56
  s_lshl_b32 s66, s66, 8
  s_and_b32 s56, s53, 1
  s_lshl_b32 s56, s56, 7
  s_add_u32 s66, s66, s56
  s_lshl_b32 s70, s3, 14
  s_add_u32 s70, s70, 93184
  s_mov_b32 s56, s70
  v_lshrrev_b32 v68, 2, v126
  v_lshl_add_u32 v68, v127, 3, v68
  v_and_b32 v69, 1, v126
  v_lshlrev_b32 v69, 3, v69
  v_bfe_u32 v70, v126, 1, 1
  v_lshl_add_u32 v69, v70, 2, v69
  v_and_b32 v70, 15, v68
  v_xor_b32 v70, v70, v69
  v_lshlrev_b32 v70, 4, v70
  v_lshl_add_u32 v70, v68, 9, v70
  v_add_u32 v12, s56, v70
  v_add_u32 v68, 4, v68
  v_and_b32 v70, 15, v68
  v_xor_b32 v70, v70, v69
  v_lshlrev_b32 v70, 4, v70
  v_lshl_add_u32 v70, v68, 9, v70
  v_add_u32 v13, s56, v70
  v_and_b32 v68, 1, v126
  v_lshlrev_b32 v69, 20, v68
  v_lshrrev_b32 v70, 1, v126
  v_lshl_add_u32 v69, v70, 8, v69
  v_lshl_add_u32 v16, v127, 5, v69
  s_mov_b32 s95, 0x0c0c0400
  s_mov_b32 s96, 0x04000c0c
  s_mov_b32 s97, 0xff
  s_lshl_b32 s56, s3, 10
  s_add_u32 s56, s56, 81920
  v_lshlrev_b32 v68, 6, v68
  v_lshl_add_u32 v68, v127, 4, v68
  v_add_u32 v24, s56, v68
  v_lshlrev_b32 v68, 6, v0
  v_add_u32 v17, 65536, v68
  v_lshlrev_b32 v18, 2, v0
  v_lshlrev_b32 v68, 4, v0
  v_add_u32 v26, 90112, v68
  v_add_u32 v27, 90112, v18
  v_and_b32 v68, 31, v0
  v_lshlrev_b32 v68, 4, v68
  v_add_u32 v28, 90112, v68
  v_mov_b32 v25, v68
  s_lshl_b32 s56, s3, 11
  s_add_u32 s56, s56, 73728
  v_add_u32 v19, s56, v68
  v_and_b32 v68, 1, v127
  v_lshlrev_b32 v69, 20, v68
  v_lshl_add_u32 v29, v126, 4, v69
  v_lshlrev_b32 v69, 11, v68
  v_lshl_add_u32 v20, v126, 4, v69
  v_lshlrev_b32 v69, 4, v126
  v_lshl_add_u32 v21, v127, 8, v69
  v_lshlrev_b32 v22, 3, v126
  v_lshl_add_u32 v22, v68, 2, v22
  v_lshrrev_b32 v68, 1, v127
  v_lshl_add_u32 v22, v68, 1, v22
  s_waitcnt vmcnt(0)
  s_barrier
  s_lshl_b32 s57, s52, 14
  s_add_u32 s57, s57, 262144
  s_mov_b32 s67, 16384
L_tally:
  buffer_load_dword v23, off, s[44:47], 0 sc1
  s_waitcnt vmcnt(0)
  v_readfirstlane_b32 s98, v23
  s_nop 0
  s_and_b32 s56, s98, 0xff
  s_cmp_eq_u32 s56, 96
  s_cbranch_scc1 L_tallied
  s_sleep 16
  s_sub_u32 s67, s67, 1
  s_cbranch_scc0 L_tally
L_tallied:
  s_lshr_b32 s56, s98, 24
  s_cmp_gt_u32 s56, 16
  s_cselect_b32 s56, 0x2000, 0
  s_xor_b32 s64, s64, s56
  s_xor_b32 s65, s65, s56
  s_lshr_b32 s57, s53, 2
  s_xor_b32 s57, s57, s52
  s_and_b32 s57, s57, 1
  s_bfe_u32 s56, s98, 0x80008
  s_cmp_eq_u32 s56, 16
  s_cselect_b32 s69, s53, 0
  s_and_b32 s69, s69, 1
  s_cmp_gt_u32 s56, 16
  s_cselect_b32 s56, 1, 0
  s_xor_b32 s69, s69, s56
  s_xor_b32 s69, s69, s57
  s_lshl_b32 s56, s69, 13
  v_mov_b32 v68, s56
  s_bfe_u32 s56, s98, 0x80010
  s_cmp_eq_u32 s56, 16
  s_cselect_b32 s88, s53, 0
  s_and_b32 s88, s88, 1
  s_cmp_gt_u32 s56, 16
  s_cselect_b32 s56, 1, 0
  s_xor_b32 s88, s88, s56
  s_xor_b32 s88, s88, s57
  s_lshl_b32 s56, s88, 13
  v_mov_b32 v69, s56
  v_mov_b32 v70, 92160
  ds_write_b64 v70, v[68:69]
  s_lshl_b32 s56, s69, 6
  s_add_u32 s55, s61, s56
  s_lshl_b32 s56, s88, 6
  s_add_u32 s99, s99, s56
  s_lshl_b32 s71, s3, 10
  s_add_u32 s71, s71, s99
  s_waitcnt lgkmcnt(0)
  v_perm_b32 v68, v85, v84, s95
  v_perm_b32 v69, v87, v86, s96
  v_or_b32 v68, v68, v69
  s_nop 0
  v_readfirstlane_b32 s56, v68
  s_nop 0
  s_mul_i32 s94, s56, 0x9e3779b1
  s_add_u32 s94, s94, 0x7f4a7c15
  s_lshr_b32 s57, s94, 15
  s_xor_b32 s94, s94, s57
  s_xor_b32 s57, s94, 2
  s_cmp_eq_u32 s94, s56
  s_cselect_b32 s94, s57, s94
  v_mov_b32 v23, s94
  v_lshrrev_b32 v112, 0, v23
  v_lshrrev_b32 v113, 8, v23
  v_lshrrev_b32 v114, 16, v23
  v_lshrrev_b32 v115, 24, v23
  s_barrier
  s_add_u32 m0, s62, 32768
  s_add_u32 s56, s55, 1024
  buffer_load_dwordx4 v4, s[28:31], s56 offen  lds
  s_add_u32 m0, s62, 33792
  s_add_u32 s56, s55, 33792
  buffer_load_dwordx4 v5, s[28:31], s56 offen  lds
  s_waitcnt vmcnt(1)
  s_add_u32 m0, s62, 34816
  s_add_u32 s56, s55, 66560
  buffer_load_dwordx4 v6, s[28:31], s56 offen  lds
  s_waitcnt vmcnt(1)
  s_add_u32 m0, s62, 35840
  s_add_u32 s56, s55, 99328
  buffer_load_dwordx4 v7, s[28:31], s56 offen  lds
  s_waitcnt vmcnt(1)
  s_add_u32 m0, s62, 36864
  s_add_u32 s56, s55, 132096
  buffer_load_dwordx4 v8, s[28:31], s56 offen  lds
  s_waitcnt vmcnt(1)
  s_add_u32 m0, s62, 37888
  s_add_u32 s56, s55, 164864
  buffer_load_dwordx4 v9, s[28:31], s56 offen  lds
  s_waitcnt vmcnt(1)
  s_add_u32 m0, s62, 38912
  s_add_u32 s56, s55, 197632
  buffer_load_dwordx4 v10, s[28:31], s56 offen  lds
  s_waitcnt vmcnt(1)
  s_add_u32 m0, s62, 39936
  s_add_u32 s56, s55, 230400
  buffer_load_dwordx4 v11, s[28:31], s56 offen  lds
  s_waitcnt vmcnt(0)
  s_barrier
  s_cmp_eq_u32 s3, 3
  s_cbranch_scc0 L_fo
  ds_read_b128 v[32:35], v17 offset:8192
  ds_read_b128 v[36:39], v17 offset:8208
  ds_read_b128 v[40:43], v17 offset:8224
  ds_read_b128 v[44:47], v17 offset:8240
  s_waitcnt lgkmcnt(0)
  v_add_f32 v32, v32, v40
  v_add_f32 v33, v33, v41
  v_add_f32 v34, v34, v42
  v_add_f32 v35, v35, v43
  v_add_f32 v36, v36, v44
  v_add_f32 v37, v37, v45
  v_add_f32 v38, v38, v46
  v_add_f32 v39, v39, v47
  v_add_f32 v32, v32, v36
  v_add_f32 v33, v33, v37
  v_add_f32 v34, v34, v38
  v_add_f32 v35, v35, v39
  v_add_f32 v32, v32, v34
  v_add_f32 v33, v33, v35
  v_add_f32 v64, v32, v33
  ds_read_b128 v[32:35], v17 offset:12288
  ds_read_b128 v[36:39], v17 offset:12304
  ds_read_b128 v[40:43], v17 offset:12320
  ds_read_b128 v[44:47], v17 offset:12336
  s_waitcnt lgkmcnt(0)
  v_add_f32 v32, v32, v40
  v_add_f32 v33, v33, v41
  v_add_f32 v34, v34, v42
  v_add_f32 v35, v35, v43
  v_add_f32 v36, v36, v44
  v_add_f32 v37, v37, v45
  v_add_f32 v38, v38, v46
  v_add_f32 v39, v39, v47
  v_add_f32 v32, v32, v36
  v_add_f32 v33, v33, v37
  v_add_f32 v34, v34, v38
  v_add_f32 v35, v35, v39
  v_add_f32 v32, v32, v34
  v_add_f32 v33, v33, v35
  v_add_f32 v65, v32, v33
  ds_write_b32 v27, v64
  ds_write_b32 v27, v65 offset:256
  s_waitcnt lgkmcnt(0)
  ds_read_b128 v[32:35], v28
  s_waitcnt lgkmcnt(0)
  v_bfi_b32 v116, s97, v112, v32
  v_bfi_b32 v117, s97, v113, v33
  v_bfi_b32 v118, s97, v114, v34
  v_bfi_b32 v119, s97, v115, v35
  s_lshr_b32 s56, s53, 2
  s_cmp_eq_u32 s56, s69
  s_cbranch_scc1 L_fo
  s_lshl_b32 s56, s2, 9
  s_add_u32 s56, s56, 786432
  s_mov_b32 exec_hi, 0
  buffer_store_dwordx4 v[116:119], v25, s[48:51], s56 offen sc1
  s_mov_b64 exec, -1
L_fo:
  s_add_u32 m0, s62, 0
  s_add_u32 s56, s55, 2048
  buffer_load_dwordx4 v4, s[28:31], s56 offen  lds
  s_add_u32 m0, s62, 1024
  s_add_u32 s56, s55, 34816
  buffer_load_dwordx4 v5, s[28:31], s56 offen  lds
  s_waitcnt vmcnt(0)
  s_add_u32 m0, s62, 2048
  s_add_u32 s56, s55, 67584
  buffer_load_dwordx4 v6, s[28:31], s56 offen  lds
  s_add_u32 m0, s62, 3072
  s_add_u32 s56, s55, 100352
  buffer_load_dwordx4 v7, s[28:31], s56 offen  lds
  s_waitcnt vmcnt(0)
  s_add_u32 m0, s62, 4096
  s_add_u32 s56, s55, 133120
  buffer_load_dwordx4 v8, s[28:31], s56 offen  lds
  s_add_u32 m0, s62, 5120
  s_add_u32 s56, s55, 165888
  buffer_load_dwordx4 v9, s[28:31], s56 offen  lds
  s_waitcnt vmcnt(0)
  s_add_u32 m0, s62, 6144
  s_add_u32 s56, s55, 198656
  buffer_load_dwordx4 v10, s[28:31], s56 offen  lds
  s_add_u32 m0, s62, 7168
  s_add_u32 s56, s55, 231424
  buffer_load_dwordx4 v11, s[28:31], s56 offen  lds
  s_waitcnt vmcnt(0)
  s_barrier
  s_add_u32 m0, s62, 32768
  s_add_u32 s56, s55, 3072
  buffer_load_dwordx4 v4, s[28:31], s56 offen  lds
  s_add_u32 m0, s62, 33792
  s_add_u32 s56, s55, 35840
  buffer_load_dwordx4 v5, s[28:31], s56 offen  lds
  s_waitcnt vmcnt(0)
  s_add_u32 m0, s62, 34816
  s_add_u32 s56, s55, 68608
  buffer_load_dwordx4 v6, s[28:31], s56 offen  lds
  s_add_u32 m0, s62, 35840
  s_add_u32 s56, s55, 101376
  buffer_load_dwordx4 v7, s[28:31], s56 offen  lds
  s_waitcnt vmcnt(0)
  s_add_u32 m0, s62, 36864
  s_add_u32 s56, s55, 134144
  buffer_load_dwordx4 v8, s[28:31], s56 offen  lds
  s_add_u32 m0, s62, 37888
  s_add_u32 s56, s55, 166912
  buffer_load_dwordx4 v9, s[28:31], s56 offen  lds
  s_waitcnt vmcnt(0)
  s_add_u32 m0, s62, 38912
  s_add_u32 s56, s55, 199680
  buffer_load_dwordx4 v10, s[28:31], s56 offen  lds
  s_add_u32 m0, s62, 39936
  s_add_u32 s56, s55, 232448
  buffer_load_dwordx4 v11, s[28:31], s56 offen  lds
  s_waitcnt vmcnt(0)
  s_barrier
  s_cmp_eq_u32 s3, 3
  s_cbranch_scc0 L_fi
  s_lshr_b32 s56, s53, 2
  s_cmp_eq_u32 s56, s69
  s_cbranch_scc1 L_fi
  s_xor_b32 s56, s2, 4
  s_lshl_b32 s56, s56, 9
  s_add_u32 s56, s56, 786432
  s_mov_b32 s67, 1048576
L_fi_poll:
  buffer_load_dwordx4 v[116:119], v25, s[48:51], s56 offen sc1
  s_waitcnt vmcnt(0)
  v_perm_b32 v68, v117, v116, s95
  v_perm_b32 v69, v119, v118, s96
  v_or_b32 v68, v68, v69
  v_xor_b32 v68, s94, v68
  v_cmp_ne_u32 vcc, 0, v68
  s_nop 1
  s_cbranch_vccz L_fi
  s_sleep 8
  s_sub_u32 s67, s67, 1
  s_cbranch_scc0 L_fi_poll
L_fi:
  s_add_u32 m0, s62, 0
  s_add_u32 s56, s55, 0
  buffer_load_dwordx4 v4, s[28:31], s56 offen  lds
  s_add_u32 m0, s62, 1024
  s_add_u32 s56, s55, 32768
  buffer_load_dwordx4 v5, s[28:31], s56 offen  lds
  s_waitcnt vmcnt(1)
  s_add_u32 m0, s62, 2048
  s_add_u32 s56, s55, 65536
  buffer_load_dwordx4 v6, s[28:31], s56 offen  lds
  s_waitcnt vmcnt(1)
  s_add_u32 m0, s62, 3072
  s_add_u32 s56, s55, 98304
  buffer_load_dwordx4 v7, s[28:31], s56 offen  lds
  s_waitcnt vmcnt(1)
  s_add_u32 m0, s62, 4096
  s_add_u32 s56, s55, 131072
  buffer_load_dwordx4 v8, s[28:31], s56 offen  lds
  s_waitcnt vmcnt(1)
  s_add_u32 m0, s62, 5120
  s_add_u32 s56, s55, 163840
  buffer_load_dwordx4 v9, s[28:31], s56 offen  lds
  s_waitcnt vmcnt(1)
  s_add_u32 m0, s62, 6144
  s_add_u32 s56, s55, 196608
  buffer_load_dwordx4 v10, s[28:31], s56 offen  lds
  s_waitcnt vmcnt(1)
  s_add_u32 m0, s62, 7168
  s_add_u32 s56, s55, 229376
  buffer_load_dwordx4 v11, s[28:31], s56 offen  lds
  s_waitcnt vmcnt(0)
  s_add_u32 m0, s70, 0
  s_add_u32 s56, s71, 0
  buffer_load_dwordx4 v4, s[32:35], s56 offen  lds
  s_barrier
  s_cmp_eq_u32 s3, 3
  s_cbranch_scc0 L_pub0
  ds_read_b128 v[32:35], v17 offset:0
  ds_read_b128 v[36:39], v17 offset:16
  ds_read_b128 v[40:43], v17 offset:32
  ds_read_b128 v[44:47], v17 offset:48
  s_waitcnt lgkmcnt(0)
  v_add_f32 v32, v32, v40
  v_add_f32 v33, v33, v41
  v_add_f32 v34, v34, v42
  v_add_f32 v35, v35, v43
  v_add_f32 v36, v36, v44
  v_add_f32 v37, v37, v45
  v_add_f32 v38, v38, v46
  v_add_f32 v39, v39, v47
  v_add_f32 v32, v32, v36
  v_add_f32 v33, v33, v37
  v_add_f32 v34, v34, v38
  v_add_f32 v35, v35, v39
  v_add_f32 v32, v32, v34
  v_add_f32 v33, v33, v35
  v_add_f32 v64, v32, v33
  ds_read_b128 v[32:35], v17 offset:4096
  ds_read_b128 v[36:39], v17 offset:4112
  ds_read_b128 v[40:43], v17 offset:4128
  ds_read_b128 v[44:47], v17 offset:4144
  s_waitcnt lgkmcnt(0)
  v_add_f32 v32, v32, v40
  v_add_f32 v33, v33, v41
  v_add_f32 v34, v34, v42
  v_add_f32 v35, v35, v43
  v_add_f32 v36, v36, v44
  v_add_f32 v37, v37, v45
  v_add_f32 v38, v38, v46
  v_add_f32 v39, v39, v47
  v_add_f32 v32, v32, v36
  v_add_f32 v33, v33, v37
  v_add_f32 v34, v34, v38
  v_add_f32 v35, v35, v39
  v_add_f32 v32, v32, v34
  v_add_f32 v33, v33, v35
  v_add_f32 v65, v32, v33
  ds_write_b32 v27, v64
  ds_write_b32 v27, v65 offset:256
  s_waitcnt lgkmcnt(0)
  ds_read_b128 v[32:35], v28
  s_waitcnt lgkmcnt(0)
  v_and_b32 v116, 0xffffff00, v116
  v_and_b32 v117, 0xffffff00, v117
  v_and_b32 v118, 0xffffff00, v118
  v_and_b32 v119, 0xffffff00, v119
  v_add_f32 v32, v32, v116
  v_add_f32 v33, v33, v117
  v_add_f32 v34, v34, v118
  v_add_f32 v35, v35, v119
  v_bfi_b32 v32, s97, v112, v32
  v_bfi_b32 v33, s97, v113, v33
  v_bfi_b32 v34, s97, v114, v34
  v_bfi_b32 v35, s97, v115, v35
  s_and_b32 s56, s53, 3
  s_lshl_b32 s57, s69, 2
  s_add_u32 s56, s56, s57
  s_lshl_b32 s56, s56, 8
  s_add_u32 s56, s56, s63
  s_add_u32 s56, s56, 0
  s_mov_b32 exec_hi, 0
  buffer_store_dwordx4 v[32:35], v29, s[48:51], s56 offen sc1
  s_mov_b64 exec, -1
L_pub0:
  s_add_u32 m0, s70, 1024
  s_add_u32 s56, s71, 32768
  buffer_load_dwordx4 v5, s[32:35], s56 offen  lds
  s_waitcnt vmcnt(1)
  s_add_u32 m0, s70, 2048
  s_add_u32 s56, s71, 65536
  buffer_load_dwordx4 v6, s[32:35], s56 offen  lds
  s_waitcnt vmcnt(0)
  s_add_u32 m0, s70, 3072
  s_add_u32 s56, s71, 98304
  buffer_load_dwordx4 v7, s[32:35], s56 offen  lds
  s_add_u32 m0, s70, 4096
  s_add_u32 s56, s71, 131072
  buffer_load_dwordx4 v8, s[32:35], s56 offen  lds
  s_waitcnt vmcnt(1)
  s_add_u32 m0, s70, 5120
  s_add_u32 s56, s71, 163840
  buffer_load_dwordx4 v9, s[32:35], s56 offen  lds
  s_waitcnt vmcnt(0)
  s_add_u32 m0, s70, 6144
  s_add_u32 s56, s71, 196608
  buffer_load_dwordx4 v10, s[32:35], s56 offen  lds
  s_add_u32 m0, s70, 7168
  s_add_u32 s56, s71, 229376
  buffer_load_dwordx4 v11, s[32:35], s56 offen  lds
  s_waitcnt vmcnt(1)
  s_add_u32 m0, s70, 8192
  s_add_u32 s56, s71, 262144
  buffer_load_dwordx4 v4, s[32:35], s56 offen  lds
  s_waitcnt vmcnt(0)
  s_add_u32 m0, s70, 9216
  s_add_u32 s56, s71, 294912
  buffer_load_dwordx4 v5, s[32:35], s56 offen  lds
  s_add_u32 m0, s70, 10240
  s_add_u32 s56, s71, 327680
  buffer_load_dwordx4 v6, s[32:35], s56 offen  lds
  s_waitcnt vmcnt(1)
  s_add_u32 m0, s70, 11264
  s_add_u32 s56, s71, 360448
  buffer_load_dwordx4 v7, s[32:35], s56 offen  lds
  s_waitcnt vmcnt(0)
  s_add_u32 m0, s70, 12288
  s_add_u32 s56, s71, 393216
  buffer_load_dwordx4 v8, s[32:35], s56 offen  lds
  s_add_u32 m0, s70, 13312
  s_add_u32 s56, s71, 425984
  buffer_load_dwordx4 v9, s[32:35], s56 offen  lds
  s_waitcnt vmcnt(1)
  s_add_u32 m0, s70, 14336
  s_add_u32 s56, s71, 458752
  buffer_load_dwordx4 v10, s[32:35], s56 offen  lds
  s_waitcnt vmcnt(0)
  s_add_u32 m0, s70, 15360
  s_add_u32 s56, s71, 491520
  buffer_load_dwordx4 v11, s[32:35], s56 offen  lds
  s_waitcnt vmcnt(0)
  v_xor_b32 v68, 0, v12
  v_xor_b32 v69, 0, v13
  ds_read_b64_tr_b16 a[0:1], v68 offset:0
  ds_read_b64_tr_b16 a[2:3], v69 offset:0
  ds_read_b64_tr_b16 a[8:9], v68 offset:8
  ds_read_b64_tr_b16 a[10:11], v69 offset:8
  ds_read_b64_tr_b16 a[64:65], v68 offset:256
  ds_read_b64_tr_b16 a[66:67], v69 offset:256
  ds_read_b64_tr_b16 a[72:73], v68 offset:264
  ds_read_b64_tr_b16 a[74:75], v69 offset:264
  s_waitcnt lgkmcnt(0)
  v_xor_b32 v68, 16, v12
  v_xor_b32 v69, 16, v13
  ds_read_b64_tr_b16 a[16:17], v68 offset:0
  ds_read_b64_tr_b16 a[18:19], v69 offset:0
  ds_read_b64_tr_b16 a[24:25], v68 offset:8
  ds_read_b64_tr_b16 a[26:27], v69 offset:8
  ds_read_b64_tr_b16 a[80:81], v68 offset:256
  ds_read_b64_tr_b16 a[82:83], v69 offset:256
  ds_read_b64_tr_b16 a[88:89], v68 offset:264
  ds_read_b64_tr_b16 a[90:91], v69 offset:264
  s_waitcnt lgkmcnt(0)
  v_xor_b32 v68, 32, v12
  v_xor_b32 v69, 32, v13
  ds_read_b64_tr_b16 a[32:33], v68 offset:0
  ds_read_b64_tr_b16 a[34:35], v69 offset:0
  ds_read_b64_tr_b16 a[40:41], v68 offset:8
  ds_read_b64_tr_b16 a[42:43], v69 offset:8
  ds_read_b64_tr_b16 a[96:97], v68 offset:256
  ds_read_b64_tr_b16 a[98:99], v69 offset:256
  ds_read_b64_tr_b16 a[104:105], v68 offset:264
  ds_read_b64_tr_b16 a[106:107], v69 offset:264
  s_waitcnt lgkmcnt(0)
  v_xor_b32 v68, 48, v12
  v_xor_b32 v69, 48, v13
  ds_read_b64_tr_b16 a[48:49], v68 offset:0
  ds_read_b64_tr_b16 a[50:51], v69 offset:0
  ds_read_b64_tr_b16 a[56:57], v68 offset:8
  ds_read_b64_tr_b16 a[58:59], v69 offset:8
  ds_read_b64_tr_b16 a[112:113], v68 offset:256
  ds_read_b64_tr_b16 a[114:115], v69 offset:256
  ds_read_b64_tr_b16 a[120:121], v68 offset:264
  ds_read_b64_tr_b16 a[122:123], v69 offset:264
  s_waitcnt lgkmcnt(0)
  s_cmp_eq_u32 s3, 0
  s_cbranch_scc0 L_sm0
  s_add_u32 s56, s63, 0
  s_mov_b32 s67, 1048576
L_sc0:
  buffer_load_dwordx4 v[32:35], v16, s[48:51], s56 offen offset:0 sc1
  buffer_load_dwordx4 v[36:39], v16, s[48:51], s56 offen offset:16 sc1
  buffer_load_dwordx4 v[40:43], v16, s[48:51], s56 offen offset:128 sc1
  buffer_load_dwordx4 v[44:47], v16, s[48:51], s56 offen offset:144 sc1
  s_waitcnt vmcnt(0)
  v_perm_b32 v68, v33, v32, s95
  v_perm_b32 v69, v35, v34, s96
  v_perm_b32 v70, v37, v36, s95
  v_perm_b32 v71, v39, v38, s96
  v_perm_b32 v72, v41, v40, s95
  v_perm_b32 v73, v43, v42, s96
  v_perm_b32 v74, v45, v44, s95
  v_perm_b32 v75, v47, v46, s96
  v_or_b32 v68, v68, v69
  v_or_b32 v70, v70, v71
  v_or_b32 v72, v72, v73
  v_or_b32 v74, v74, v75
  v_xor_b32 v68, s94, v68
  v_xor_b32 v70, s94, v70
  v_xor_b32 v72, s94, v72
  v_xor_b32 v74, s94, v74
  v_or_b32 v68, v68, v70
  v_or_b32 v68, v68, v72
  v_or_b32 v68, v68, v74
  v_cmp_ne_u32 vcc, 0, v68
  s_nop 1
  s_cbranch_vccz L_sc_ok0
  s_sleep 8
  s_sub_u32 s67, s67, 1
  s_cbranch_scc0 L_sc0
L_sc_ok0:
  v_and_b32 v32, 0xffffff00, v32
  v_and_b32 v33, 0xffffff00, v33
  v_and_b32 v34, 0xffffff00, v34
  v_and_b32 v35, 0xffffff00, v35
  v_and_b32 v36, 0xffffff00, v36
  v_and_b32 v37, 0xffffff00, v37
  v_and_b32 v38, 0xffffff00, v38
  v_and_b32 v39, 0xffffff00, v39
  v_and_b32 v40, 0xffffff00, v40
  v_and_b32 v41, 0xffffff00, v41
  v_and_b32 v42, 0xffffff00, v42
  v_and_b32 v43, 0xffffff00, v43
  v_and_b32 v44, 0xffffff00, v44
  v_and_b32 v45, 0xffffff00, v45
  v_and_b32 v46, 0xffffff00, v46
  v_and_b32 v47, 0xffffff00, v47
  v_add_f32_dpp v32, v32, v32 quad_perm:[2,3,0,1] row_mask:0xf bank_mask:0xf
  v_add_f32_dpp v33, v33, v33 quad_perm:[2,3,0,1] row_mask:0xf bank_mask:0xf
  v_add_f32_dpp v34, v34, v34 quad_perm:[2,3,0,1] row_mask:0xf bank_mask:0xf
  v_add_f32_dpp v35, v35, v35 quad_perm:[2,3,0,1] row_mask:0xf bank_mask:0xf
  v_add_f32_dpp v36, v36, v36 quad_perm:[2,3,0,1] row_mask:0xf bank_mask:0xf
  v_add_f32_dpp v37, v37, v37 quad_perm:[2,3,0,1] row_mask:0xf bank_mask:0xf
  v_add_f32_dpp v38, v38, v38 quad_perm:[2,3,0,1] row_mask:0xf bank_mask:0xf
  v_add_f32_dpp v39, v39, v39 quad_perm:[2,3,0,1] row_mask:0xf bank_mask:0xf
  v_add_f32_dpp v40, v40, v40 quad_perm:[2,3,0,1] row_mask:0xf bank_mask:0xf
  v_add_f32_dpp v41, v41, v41 quad_perm:[2,3,0,1] row_mask:0xf bank_mask:0xf
  v_add_f32_dpp v42, v42, v42 quad_perm:[2,3,0,1] row_mask:0xf bank_mask:0xf
  v_add_f32_dpp v43, v43, v43 quad_perm:[2,3,0,1] row_mask:0xf bank_mask:0xf
  v_add_f32_dpp v44, v44, v44 quad_perm:[2,3,0,1] row_mask:0xf bank_mask:0xf
  v_add_f32_dpp v45, v45, v45 quad_perm:[2,3,0,1] row_mask:0xf bank_mask:0xf
  v_add_f32_dpp v46, v46, v46 quad_perm:[2,3,0,1] row_mask:0xf bank_mask:0xf
  v_add_f32_dpp v47, v47, v47 quad_perm:[2,3,0,1] row_mask:0xf bank_mask:0xf
  v_add_f32_dpp v32, v32, v32 row_ror:4 row_mask:0xf bank_mask:0xf
  v_add_f32_dpp v33, v33, v33 row_ror:4 row_mask:0xf bank_mask:0xf
  v_add_f32_dpp v34, v34, v34 row_ror:4 row_mask:0xf bank_mask:0xf
  v_add_f32_dpp v35, v35, v35 row_ror:4 row_mask:0xf bank_mask:0xf
  v_add_f32_dpp v36, v36, v36 row_ror:4 row_mask:0xf bank_mask:0xf
  v_add_f32_dpp v37, v37, v37 row_ror:4 row_mask:0xf bank_mask:0xf
  v_add_f32_dpp v38, v38, v38 row_ror:4 row_mask:0xf bank_mask:0xf
  v_add_f32_dpp v39, v39, v39 row_ror:4 row_mask:0xf bank_mask:0xf
  v_add_f32_dpp v40, v40, v40 row_ror:4 row_mask:0xf bank_mask:0xf
  v_add_f32_dpp v41, v41, v41 row_ror:4 row_mask:0xf bank_mask:0xf
  v_add_f32_dpp v42, v42, v42 row_ror:4 row_mask:0xf bank_mask:0xf
  v_add_f32_dpp v43, v43, v43 row_ror:4 row_mask:0xf bank_mask:0xf
  v_add_f32_dpp v44, v44, v44 row_ror:4 row_mask:0xf bank_mask:0xf
  v_add_f32_dpp v45, v45, v45 row_ror:4 row_mask:0xf bank_mask:0xf
  v_add_f32_dpp v46, v46, v46 row_ror:4 row_mask:0xf bank_mask:0xf
  v_add_f32_dpp v47, v47, v47 row_ror:4 row_mask:0xf bank_mask:0xf
  v_add_f32_dpp v32, v32, v32 row_ror:8 row_mask:0xf bank_mask:0xf
  v_add_f32_dpp v33, v33, v33 row_ror:8 row_mask:0xf bank_mask:0xf
  v_add_f32_dpp v34, v34, v34 row_ror:8 row_mask:0xf bank_mask:0xf
  v_add_f32_dpp v35, v35, v35 row_ror:8 row_mask:0xf bank_mask:0xf
  v_add_f32_dpp v36, v36, v36 row_ror:8 row_mask:0xf bank_mask:0xf
  v_add_f32_dpp v37, v37, v37 row_ror:8 row_mask:0xf bank_mask:0xf
  v_add_f32_dpp v38, v38, v38 row_ror:8 row_mask:0xf bank_mask:0xf
  v_add_f32_dpp v39, v39, v39 row_ror:8 row_mask:0xf bank_mask:0xf
  v_add_f32_dpp v40, v40, v40 row_ror:8 row_mask:0xf bank_mask:0xf
  v_add_f32_dpp v41, v41, v41 row_ror:8 row_mask:0xf bank_mask:0xf
  v_add_f32_dpp v42, v42, v42 row_ror:8 row_mask:0xf bank_mask:0xf
  v_add_f32_dpp v43, v43, v43 row_ror:8 row_mask:0xf bank_mask:0xf
  v_add_f32_dpp v44, v44, v44 row_ror:8 row_mask:0xf bank_mask:0xf
  v_add_f32_dpp v45, v45, v45 row_ror:8 row_mask:0xf bank_mask:0xf
  v_add_f32_dpp v46, v46, v46 row_ror:8 row_mask:0xf bank_mask:0xf
  v_add_f32_dpp v47, v47, v47 row_ror:8 row_mask:0xf bank_mask:0xf
  v_max3_f32 v70, v32, v33, v34
  v_max3_f32 v70, v70, v35, v36
  v_max3_f32 v70, v70, v37, v38
  v_max3_f32 v70, v70, v39, v40
  v_max3_f32 v70, v70, v41, v42
  v_max3_f32 v70, v70, v43, v44
  v_max3_f32 v70, v70, v45, v46
  v_max3_f32 v70, v70, v47, v47
  v_mov_b32 v69, v70
  s_nop 1
  v_permlane32_swap_b32 v69, v70
  v_max_f32 v70, v69, v70
  v_mov_b32 v69, v70
  s_nop 1
  v_permlane16_swap_b32 v69, v70
  v_max_f32 v70, v69, v70
  v_mul_f32 v70, s60, v70
  v_fma_f32 v32, v32, s60, -v70
  v_fma_f32 v33, v33, s60, -v70
  v_fma_f32 v34, v34, s60, -v70
  v_fma_f32 v35, v35, s60, -v70
  v_fma_f32 v36, v36, s60, -v70
  v_fma_f32 v37, v37, s60, -v70
  v_fma_f32 v38, v38, s60, -v70
  v_fma_f32 v39, v39, s60, -v70
  v_fma_f32 v40, v40, s60, -v70
  v_fma_f32 v41, v41, s60, -v70
  v_fma_f32 v42, v42, s60, -v70
  v_fma_f32 v43, v43, s60, -v70
  v_fma_f32 v44, v44, s60, -v70
  v_fma_f32 v45, v45, s60, -v70
  v_fma_f32 v46, v46, s60, -v70
  v_fma_f32 v47, v47, s60, -v70
  v_exp_f32 v32, v32
  v_exp_f32 v33, v33
  v_exp_f32 v34, v34
  v_exp_f32 v35, v35
  v_exp_f32 v36, v36
  v_exp_f32 v37, v37
  v_exp_f32 v38, v38
  v_exp_f32 v39, v39
  v_exp_f32 v40, v40
  v_exp_f32 v41, v41
  v_exp_f32 v42, v42
  v_exp_f32 v43, v43
  v_exp_f32 v44, v44
  v_exp_f32 v45, v45
  v_exp_f32 v46, v46
  v_exp_f32 v47, v47
  v_add_f32 v72, v32, v36
  v_add_f32 v73, v33, v37
  v_add_f32 v74, v34, v38
  v_add_f32 v75, v35, v39
  v_add_f32 v76, v40, v44
  v_add_f32 v77, v41, v45
  v_add_f32 v78, v42, v46
  v_add_f32 v79, v43, v47
  v_add_f32 v72, v72, v76
  v_add_f32 v73, v73, v77
  v_add_f32 v74, v74, v78
  v_add_f32 v75, v75, v79
  v_add_f32 v72, v72, v73
  v_add_f32 v74, v74, v75
  v_add_f32 v71, v72, v74
  v_mov_b32 v69, v71
  s_nop 1
  v_permlane32_swap_b32 v69, v71
  v_add_f32 v71, v69, v71
  v_mov_b32 v69, v71
  s_nop 1
  v_permlane16_swap_b32 v69, v71
  v_add_f32 v71, v69, v71
  v_rcp_f32 v71, v71
  s_nop 0
  v_mul_f32 v32, v32, v71
  v_mul_f32 v33, v33, v71
  v_mul_f32 v34, v34, v71
  v_mul_f32 v35, v35, v71
  v_mul_f32 v36, v36, v71
  v_mul_f32 v37, v37, v71
  v_mul_f32 v38, v38, v71
  v_mul_f32 v39, v39, v71
  v_mul_f32 v40, v40, v71
  v_mul_f32 v41, v41, v71
  v_mul_f32 v42, v42, v71
  v_mul_f32 v43, v43, v71
  v_mul_f32 v44, v44, v71
  v_mul_f32 v45, v45, v71
  v_mul_f32 v46, v46, v71
  v_mul_f32 v47, v47, v71
  v_cvt_pk_bf16_f32 v48, v32, v33
  v_cvt_pk_bf16_f32 v49, v34, v35
  v_cvt_pk_bf16_f32 v50, v36, v37
  v_cvt_pk_bf16_f32 v51, v38, v39
  v_cvt_pk_bf16_f32 v52, v40, v41
  v_cvt_pk_bf16_f32 v53, v42, v43
  v_cvt_pk_bf16_f32 v54, v44, v45
  v_cvt_pk_bf16_f32 v55, v46, v47
  ds_write_b128 v26, v[48:51]
  ds_write_b128 v26, v[52:55] offset:1024
  s_waitcnt lgkmcnt(0)
L_sm0:
  s_add_u32 m0, s70, 0
  s_add_u32 s56, s71, 524288
  buffer_load_dwordx4 v4, s[32:35], s56 offen  lds
  s_add_u32 m0, s70, 1024
  s_add_u32 s56, s71, 557056
  buffer_load_dwordx4 v5, s[32:35], s56 offen  lds
  s_waitcnt vmcnt(1)
  s_add_u32 m0, s70, 2048
  s_add_u32 s56, s71, 589824
  buffer_load_dwordx4 v6, s[32:35], s56 offen  lds
  s_waitcnt vmcnt(0)
  s_add_u32 m0, s70, 3072
  s_add_u32 s56, s71, 622592
  buffer_load_dwordx4 v7, s[32:35], s56 offen  lds
  s_add_u32 m0, s70, 4096
  s_add_u32 s56, s71, 655360
  buffer_load_dwordx4 v8, s[32:35], s56 offen  lds
  s_waitcnt vmcnt(1)
  s_add_u32 m0, s70, 5120
  s_add_u32 s56, s71, 688128
  buffer_load_dwordx4 v9, s[32:35], s56 offen  lds
  s_waitcnt vmcnt(0)
  s_add_u32 m0, s70, 6144
  s_add_u32 s56, s71, 720896
  buffer_load_dwordx4 v10, s[32:35], s56 offen  lds
  s_add_u32 m0, s70, 7168
  s_add_u32 s56, s71, 753664
  buffer_load_dwordx4 v11, s[32:35], s56 offen  lds
  s_waitcnt vmcnt(1)
  s_add_u32 m0, s70, 8192
  s_add_u32 s56, s71, 786432
  buffer_load_dwordx4 v4, s[32:35], s56 offen  lds
  s_waitcnt vmcnt(0)
  s_add_u32 m0, s70, 9216
  s_add_u32 s56, s71, 819200
  buffer_load_dwordx4 v5, s[32:35], s56 offen  lds
  s_add_u32 m0, s70, 10240
  s_add_u32 s56, s71, 851968
  buffer_load_dwordx4 v6, s[32:35], s56 offen  lds
  s_waitcnt vmcnt(1)
  s_add_u32 m0, s70, 11264
  s_add_u32 s56, s71, 884736
  buffer_load_dwordx4 v7, s[32:35], s56 offen  lds
  s_waitcnt vmcnt(0)
  s_add_u32 m0, s70, 12288
  s_add_u32 s56, s71, 917504
  buffer_load_dwordx4 v8, s[32:35], s56 offen  lds
  s_add_u32 m0, s70, 13312
  s_add_u32 s56, s71, 950272
  buffer_load_dwordx4 v9, s[32:35], s56 offen  lds
  s_waitcnt vmcnt(1)
  s_add_u32 m0, s70, 14336
  s_add_u32 s56, s71, 983040
  buffer_load_dwordx4 v10, s[32:35], s56 offen  lds
  s_waitcnt vmcnt(0)
  s_add_u32 m0, s70, 15360
  s_add_u32 s56, s71, 1015808
  buffer_load_dwordx4 v11, s[32:35], s56 offen  lds
  s_waitcnt vmcnt(0)
  v_xor_b32 v68, 0, v12
  v_xor_b32 v69, 0, v13
  ds_read_b64_tr_b16 a[4:5], v68 offset:0
  ds_read_b64_tr_b16 a[6:7], v69 offset:0
  ds_read_b64_tr_b16 a[12:13], v68 offset:8
  ds_read_b64_tr_b16 a[14:15], v69 offset:8
  ds_read_b64_tr_b16 a[68:69], v68 offset:256
  ds_read_b64_tr_b16 a[70:71], v69 offset:256
  ds_read_b64_tr_b16 a[76:77], v68 offset:264
  ds_read_b64_tr_b16 a[78:79], v69 offset:264
  s_waitcnt lgkmcnt(0)
  v_xor_b32 v68, 16, v12
  v_xor_b32 v69, 16, v13
  ds_read_b64_tr_b16 a[20:21], v68 offset:0
  ds_read_b64_tr_b16 a[22:23], v69 offset:0
  ds_read_b64_tr_b16 a[28:29], v68 offset:8
  ds_read_b64_tr_b16 a[30:31], v69 offset:8
  ds_read_b64_tr_b16 a[84:85], v68 offset:256
  ds_read_b64_tr_b16 a[86:87], v69 offset:256
  ds_read_b64_tr_b16 a[92:93], v68 offset:264
  ds_read_b64_tr_b16 a[94:95], v69 offset:264
  s_waitcnt lgkmcnt(0)
  v_xor_b32 v68, 32, v12
  v_xor_b32 v69, 32, v13
  ds_read_b64_tr_b16 a[36:37], v68 offset:0
  ds_read_b64_tr_b16 a[38:39], v69 offset:0
  ds_read_b64_tr_b16 a[44:45], v68 offset:8
  ds_read_b64_tr_b16 a[46:47], v69 offset:8
  ds_read_b64_tr_b16 a[100:101], v68 offset:256
  ds_read_b64_tr_b16 a[102:103], v69 offset:256
  ds_read_b64_tr_b16 a[108:109], v68 offset:264
  ds_read_b64_tr_b16 a[110:111], v69 offset:264
  s_waitcnt lgkmcnt(0)
  v_xor_b32 v68, 48, v12
  v_xor_b32 v69, 48, v13
  ds_read_b64_tr_b16 a[52:53], v68 offset:0
  ds_read_b64_tr_b16 a[54:55], v69 offset:0
  ds_read_b64_tr_b16 a[60:61], v68 offset:8
  ds_read_b64_tr_b16 a[62:63], v69 offset:8
  ds_read_b64_tr_b16 a[116:117], v68 offset:256
  ds_read_b64_tr_b16 a[118:119], v69 offset:256
  ds_read_b64_tr_b16 a[124:125], v68 offset:264
  ds_read_b64_tr_b16 a[126:127], v69 offset:264
  s_waitcnt lgkmcnt(0)
  s_barrier
  ds_read_b128 v[48:51], v26
  ds_read_b128 v[52:55], v26 offset:1024
  s_mov_b32 s100, 0x00030003
  s_mov_b32 s101, 0x00030003
  s_waitcnt lgkmcnt(0)
  v_mfma_f32_16x16x32_bf16 v[56:59], a[0:3], v[48:51], 0
  v_mfma_f32_16x16x32_bf16 v[60:63], a[8:11], v[48:51], 0
  v_mfma_f32_16x16x32_bf16 v[56:59], a[4:7], v[52:55], v[56:59]
  v_mfma_f32_16x16x32_bf16 v[60:63], a[12:15], v[52:55], v[60:63]
  s_nop 6
  v_cvt_pk_bf16_f32 v64, v56, v57
  v_cvt_pk_bf16_f32 v65, v58, v59
  v_cvt_pk_bf16_f32 v66, v60, v61
  v_cvt_pk_bf16_f32 v67, v62, v63
  s_mov_b64 exec, s[100:101]
  ds_write_b128 v24, v[64:67] offset:0
  s_mov_b64 exec, -1
  v_mfma_f32_16x16x32_bf16 v[56:59], a[16:19], v[48:51], 0
  v_mfma_f32_16x16x32_bf16 v[60:63], a[24:27], v[48:51], 0
  v_mfma_f32_16x16x32_bf16 v[56:59], a[20:23], v[52:55], v[56:59]
  v_mfma_f32_16x16x32_bf16 v[60:63], a[28:31], v[52:55], v[60:63]
  s_nop 6
  v_cvt_pk_bf16_f32 v64, v56, v57
  v_cvt_pk_bf16_f32 v65, v58, v59
  v_cvt_pk_bf16_f32 v66, v60, v61
  v_cvt_pk_bf16_f32 v67, v62, v63
  s_mov_b64 exec, s[100:101]
  ds_write_b128 v24, v[64:67] offset:128
  s_mov_b64 exec, -1
  v_mfma_f32_16x16x32_bf16 v[56:59], a[32:35], v[48:51], 0
  v_mfma_f32_16x16x32_bf16 v[60:63], a[40:43], v[48:51], 0
  v_mfma_f32_16x16x32_bf16 v[56:59], a[36:39], v[52:55], v[56:59]
  v_mfma_f32_16x16x32_bf16 v[60:63], a[44:47], v[52:55], v[60:63]
  s_nop 6
  v_cvt_pk_bf16_f32 v64, v56, v57
  v_cvt_pk_bf16_f32 v65, v58, v59
  v_cvt_pk_bf16_f32 v66, v60, v61
  v_cvt_pk_bf16_f32 v67, v62, v63
  s_mov_b64 exec, s[100:101]
  ds_write_b128 v24, v[64:67] offset:256
  s_mov_b64 exec, -1
  v_mfma_f32_16x16x32_bf16 v[56:59], a[48:51], v[48:51], 0
  v_mfma_f32_16x16x32_bf16 v[60:63], a[56:59], v[48:51], 0
  v_mfma_f32_16x16x32_bf16 v[56:59], a[52:55], v[52:55], v[56:59]
  v_mfma_f32_16x16x32_bf16 v[60:63], a[60:63], v[52:55], v[60:63]
  s_nop 6
  v_cvt_pk_bf16_f32 v64, v56, v57
  v_cvt_pk_bf16_f32 v65, v58, v59
  v_cvt_pk_bf16_f32 v66, v60, v61
  v_cvt_pk_bf16_f32 v67, v62, v63
  s_mov_b64 exec, s[100:101]
  ds_write_b128 v24, v[64:67] offset:384
  s_mov_b64 exec, -1
  v_mfma_f32_16x16x32_bf16 v[56:59], a[64:67], v[48:51], 0
  v_mfma_f32_16x16x32_bf16 v[60:63], a[72:75], v[48:51], 0
  v_mfma_f32_16x16x32_bf16 v[56:59], a[68:71], v[52:55], v[56:59]
  v_mfma_f32_16x16x32_bf16 v[60:63], a[76:79], v[52:55], v[60:63]
  s_nop 6
  v_cvt_pk_bf16_f32 v64, v56, v57
  v_cvt_pk_bf16_f32 v65, v58, v59
  v_cvt_pk_bf16_f32 v66, v60, v61
  v_cvt_pk_bf16_f32 v67, v62, v63
  s_mov_b64 exec, s[100:101]
  ds_write_b128 v24, v[64:67] offset:512
  s_mov_b64 exec, -1
  v_mfma_f32_16x16x32_bf16 v[56:59], a[80:83], v[48:51], 0
  v_mfma_f32_16x16x32_bf16 v[60:63], a[88:91], v[48:51], 0
  v_mfma_f32_16x16x32_bf16 v[56:59], a[84:87], v[52:55], v[56:59]
  v_mfma_f32_16x16x32_bf16 v[60:63], a[92:95], v[52:55], v[60:63]
  s_nop 6
  v_cvt_pk_bf16_f32 v64, v56, v57
  v_cvt_pk_bf16_f32 v65, v58, v59
  v_cvt_pk_bf16_f32 v66, v60, v61
  v_cvt_pk_bf16_f32 v67, v62, v63
  s_mov_b64 exec, s[100:101]
  ds_write_b128 v24, v[64:67] offset:640
  s_mov_b64 exec, -1
  v_mfma_f32_16x16x32_bf16 v[56:59], a[96:99], v[48:51], 0
  v_mfma_f32_16x16x32_bf16 v[60:63], a[104:107], v[48:51], 0
  v_mfma_f32_16x16x32_bf16 v[56:59], a[100:103], v[52:55], v[56:59]
  v_mfma_f32_16x16x32_bf16 v[60:63], a[108:111], v[52:55], v[60:63]
  s_nop 6
  v_cvt_pk_bf16_f32 v64, v56, v57
  v_cvt_pk_bf16_f32 v65, v58, v59
  v_cvt_pk_bf16_f32 v66, v60, v61
  v_cvt_pk_bf16_f32 v67, v62, v63
  s_mov_b64 exec, s[100:101]
  ds_write_b128 v24, v[64:67] offset:768
  s_mov_b64 exec, -1
  v_mfma_f32_16x16x32_bf16 v[56:59], a[112:115], v[48:51], 0
  v_mfma_f32_16x16x32_bf16 v[60:63], a[120:123], v[48:51], 0
  v_mfma_f32_16x16x32_bf16 v[56:59], a[116:119], v[52:55], v[56:59]
  v_mfma_f32_16x16x32_bf16 v[60:63], a[124:127], v[52:55], v[60:63]
  s_nop 6
  v_cvt_pk_bf16_f32 v64, v56, v57
  v_cvt_pk_bf16_f32 v65, v58, v59
  v_cvt_pk_bf16_f32 v66, v60, v61
  v_cvt_pk_bf16_f32 v67, v62, v63
  s_mov_b64 exec, s[100:101]
  ds_write_b128 v24, v[64:67] offset:896
  s_mov_b64 exec, -1
  s_waitcnt lgkmcnt(0)
  s_barrier
  s_cmp_eq_u32 s3, 3
  s_cbranch_scc0 L_pub1
  ds_read_b128 v[32:35], v17 offset:0
  ds_read_b128 v[36:39], v17 offset:16
  ds_read_b128 v[40:43], v17 offset:32
  ds_read_b128 v[44:47], v17 offset:48
  s_waitcnt lgkmcnt(0)
  v_add_f32 v32, v32, v40
  v_add_f32 v33, v33, v41
  v_add_f32 v34, v34, v42
  v_add_f32 v35, v35, v43
  v_add_f32 v36, v36, v44
  v_add_f32 v37, v37, v45
  v_add_f32 v38, v38, v46
  v_add_f32 v39, v39, v47
  v_add_f32 v32, v32, v36
  v_add_f32 v33, v33, v37
  v_add_f32 v34, v34, v38
  v_add_f32 v35, v35, v39
  v_add_f32 v32, v32, v34
  v_add_f32 v33, v33, v35
  v_add_f32 v64, v32, v33
  ds_read_b128 v[32:35], v17 offset:4096
  ds_read_b128 v[36:39], v17 offset:4112
  ds_read_b128 v[40:43], v17 offset:4128
  ds_read_b128 v[44:47], v17 offset:4144
  s_waitcnt lgkmcnt(0)
  v_add_f32 v32, v32, v40
  v_add_f32 v33, v33, v41
  v_add_f32 v34, v34, v42
  v_add_f32 v35, v35, v43
  v_add_f32 v36, v36, v44
  v_add_f32 v37, v37, v45
  v_add_f32 v38, v38, v46
  v_add_f32 v39, v39, v47
  v_add_f32 v32, v32, v36
  v_add_f32 v33, v33, v37
  v_add_f32 v34, v34, v38
  v_add_f32 v35, v35, v39
  v_add_f32 v32, v32, v34
  v_add_f32 v33, v33, v35
  v_add_f32 v65, v32, v33
  ds_write_b32 v27, v64
  ds_write_b32 v27, v65 offset:256
  s_waitcnt lgkmcnt(0)
  ds_read_b128 v[32:35], v28
  s_waitcnt lgkmcnt(0)
  v_bfi_b32 v32, s97, v112, v32
  v_bfi_b32 v33, s97, v113, v33
  v_bfi_b32 v34, s97, v114, v34
  v_bfi_b32 v35, s97, v115, v35
  s_and_b32 s56, s53, 3
  s_lshl_b32 s57, s69, 2
  s_add_u32 s56, s56, s57
  s_lshl_b32 s56, s56, 8
  s_add_u32 s56, s56, s63
  s_add_u32 s56, s56, 65536
  s_mov_b32 exec_hi, 0
  buffer_store_dwordx4 v[32:35], v29, s[48:51], s56 offen sc1
  s_mov_b64 exec, -1
L_pub1:
  s_barrier
  s_cmp_eq_u32 s3, 0
  s_cbranch_scc0 L_sm1
  s_add_u32 s56, s63, 65536
  s_mov_b32 s67, 1048576
L_sc1:
  buffer_load_dwordx4 v[32:35], v16, s[48:51], s56 offen offset:0 sc1
  buffer_load_dwordx4 v[36:39], v16, s[48:51], s56 offen offset:16 sc1
  buffer_load_dwordx4 v[40:43], v16, s[48:51], s56 offen offset:128 sc1
  buffer_load_dwordx4 v[44:47], v16, s[48:51], s56 offen offset:144 sc1
  s_waitcnt vmcnt(0)
  v_perm_b32 v68, v33, v32, s95
  v_perm_b32 v69, v35, v34, s96
  v_perm_b32 v70, v37, v36, s95
  v_perm_b32 v71, v39, v38, s96
  v_perm_b32 v72, v41, v40, s95
  v_perm_b32 v73, v43, v42, s96
  v_perm_b32 v74, v45, v44, s95
  v_perm_b32 v75, v47, v46, s96
  v_or_b32 v68, v68, v69
  v_or_b32 v70, v70, v71
  v_or_b32 v72, v72, v73
  v_or_b32 v74, v74, v75
  v_xor_b32 v68, s94, v68
  v_xor_b32 v70, s94, v70
  v_xor_b32 v72, s94, v72
  v_xor_b32 v74, s94, v74
  v_or_b32 v68, v68, v70
  v_or_b32 v68, v68, v72
  v_or_b32 v68, v68, v74
  v_cmp_ne_u32 vcc, 0, v68
  s_nop 1
  s_cbranch_vccz L_sc_ok1
  s_sleep 8
  s_sub_u32 s67, s67, 1
  s_cbranch_scc0 L_sc1
L_sc_ok1:
  v_and_b32 v32, 0xffffff00, v32
  v_and_b32 v33, 0xffffff00, v33
  v_and_b32 v34, 0xffffff00, v34
  v_and_b32 v35, 0xffffff00, v35
  v_and_b32 v36, 0xffffff00, v36
  v_and_b32 v37, 0xffffff00, v37
  v_and_b32 v38, 0xffffff00, v38
  v_and_b32 v39, 0xffffff00, v39
  v_and_b32 v40, 0xffffff00, v40
  v_and_b32 v41, 0xffffff00, v41
  v_and_b32 v42, 0xffffff00, v42
  v_and_b32 v43, 0xffffff00, v43
  v_and_b32 v44, 0xffffff00, v44
  v_and_b32 v45, 0xffffff00, v45
  v_and_b32 v46, 0xffffff00, v46
  v_and_b32 v47, 0xffffff00, v47
  v_add_f32_dpp v32, v32, v32 quad_perm:[2,3,0,1] row_mask:0xf bank_mask:0xf
  v_add_f32_dpp v33, v33, v33 quad_perm:[2,3,0,1] row_mask:0xf bank_mask:0xf
  v_add_f32_dpp v34, v34, v34 quad_perm:[2,3,0,1] row_mask:0xf bank_mask:0xf
  v_add_f32_dpp v35, v35, v35 quad_perm:[2,3,0,1] row_mask:0xf bank_mask:0xf
  v_add_f32_dpp v36, v36, v36 quad_perm:[2,3,0,1] row_mask:0xf bank_mask:0xf
  v_add_f32_dpp v37, v37, v37 quad_perm:[2,3,0,1] row_mask:0xf bank_mask:0xf
  v_add_f32_dpp v38, v38, v38 quad_perm:[2,3,0,1] row_mask:0xf bank_mask:0xf
  v_add_f32_dpp v39, v39, v39 quad_perm:[2,3,0,1] row_mask:0xf bank_mask:0xf
  v_add_f32_dpp v40, v40, v40 quad_perm:[2,3,0,1] row_mask:0xf bank_mask:0xf
  v_add_f32_dpp v41, v41, v41 quad_perm:[2,3,0,1] row_mask:0xf bank_mask:0xf
  v_add_f32_dpp v42, v42, v42 quad_perm:[2,3,0,1] row_mask:0xf bank_mask:0xf
  v_add_f32_dpp v43, v43, v43 quad_perm:[2,3,0,1] row_mask:0xf bank_mask:0xf
  v_add_f32_dpp v44, v44, v44 quad_perm:[2,3,0,1] row_mask:0xf bank_mask:0xf
  v_add_f32_dpp v45, v45, v45 quad_perm:[2,3,0,1] row_mask:0xf bank_mask:0xf
  v_add_f32_dpp v46, v46, v46 quad_perm:[2,3,0,1] row_mask:0xf bank_mask:0xf
  v_add_f32_dpp v47, v47, v47 quad_perm:[2,3,0,1] row_mask:0xf bank_mask:0xf
  v_add_f32_dpp v32, v32, v32 row_ror:4 row_mask:0xf bank_mask:0xf
  v_add_f32_dpp v33, v33, v33 row_ror:4 row_mask:0xf bank_mask:0xf
  v_add_f32_dpp v34, v34, v34 row_ror:4 row_mask:0xf bank_mask:0xf
  v_add_f32_dpp v35, v35, v35 row_ror:4 row_mask:0xf bank_mask:0xf
  v_add_f32_dpp v36, v36, v36 row_ror:4 row_mask:0xf bank_mask:0xf
  v_add_f32_dpp v37, v37, v37 row_ror:4 row_mask:0xf bank_mask:0xf
  v_add_f32_dpp v38, v38, v38 row_ror:4 row_mask:0xf bank_mask:0xf
  v_add_f32_dpp v39, v39, v39 row_ror:4 row_mask:0xf bank_mask:0xf
  v_add_f32_dpp v40, v40, v40 row_ror:4 row_mask:0xf bank_mask:0xf
  v_add_f32_dpp v41, v41, v41 row_ror:4 row_mask:0xf bank_mask:0xf
  v_add_f32_dpp v42, v42, v42 row_ror:4 row_mask:0xf bank_mask:0xf
  v_add_f32_dpp v43, v43, v43 row_ror:4 row_mask:0xf bank_mask:0xf
  v_add_f32_dpp v44, v44, v44 row_ror:4 row_mask:0xf bank_mask:0xf
  v_add_f32_dpp v45, v45, v45 row_ror:4 row_mask:0xf bank_mask:0xf
  v_add_f32_dpp v46, v46, v46 row_ror:4 row_mask:0xf bank_mask:0xf
  v_add_f32_dpp v47, v47, v47 row_ror:4 row_mask:0xf bank_mask:0xf
  v_add_f32_dpp v32, v32, v32 row_ror:8 row_mask:0xf bank_mask:0xf
  v_add_f32_dpp v33, v33, v33 row_ror:8 row_mask:0xf bank_mask:0xf
  v_add_f32_dpp v34, v34, v34 row_ror:8 row_mask:0xf bank_mask:0xf
  v_add_f32_dpp v35, v35, v35 row_ror:8 row_mask:0xf bank_mask:0xf
  v_add_f32_dpp v36, v36, v36 row_ror:8 row_mask:0xf bank_mask:0xf
  v_add_f32_dpp v37, v37, v37 row_ror:8 row_mask:0xf bank_mask:0xf
  v_add_f32_dpp v38, v38, v38 row_ror:8 row_mask:0xf bank_mask:0xf
  v_add_f32_dpp v39, v39, v39 row_ror:8 row_mask:0xf bank_mask:0xf
  v_add_f32_dpp v40, v40, v40 row_ror:8 row_mask:0xf bank_mask:0xf
  v_add_f32_dpp v41, v41, v41 row_ror:8 row_mask:0xf bank_mask:0xf
  v_add_f32_dpp v42, v42, v42 row_ror:8 row_mask:0xf bank_mask:0xf
  v_add_f32_dpp v43, v43, v43 row_ror:8 row_mask:0xf bank_mask:0xf
  v_add_f32_dpp v44, v44, v44 row_ror:8 row_mask:0xf bank_mask:0xf
  v_add_f32_dpp v45, v45, v45 row_ror:8 row_mask:0xf bank_mask:0xf
  v_add_f32_dpp v46, v46, v46 row_ror:8 row_mask:0xf bank_mask:0xf
  v_add_f32_dpp v47, v47, v47 row_ror:8 row_mask:0xf bank_mask:0xf
  v_max3_f32 v70, v32, v33, v34
  v_max3_f32 v70, v70, v35, v36
  v_max3_f32 v70, v70, v37, v38
  v_max3_f32 v70, v70, v39, v40
  v_max3_f32 v70, v70, v41, v42
  v_max3_f32 v70, v70, v43, v44
  v_max3_f32 v70, v70, v45, v46
  v_max3_f32 v70, v70, v47, v47
  v_mov_b32 v69, v70
  s_nop 1
  v_permlane32_swap_b32 v69, v70
  v_max_f32 v70, v69, v70
  v_mov_b32 v69, v70
  s_nop 1
  v_permlane16_swap_b32 v69, v70
  v_max_f32 v70, v69, v70
  v_mul_f32 v70, s60, v70
  v_fma_f32 v32, v32, s60, -v70
  v_fma_f32 v33, v33, s60, -v70
  v_fma_f32 v34, v34, s60, -v70
  v_fma_f32 v35, v35, s60, -v70
  v_fma_f32 v36, v36, s60, -v70
  v_fma_f32 v37, v37, s60, -v70
  v_fma_f32 v38, v38, s60, -v70
  v_fma_f32 v39, v39, s60, -v70
  v_fma_f32 v40, v40, s60, -v70
  v_fma_f32 v41, v41, s60, -v70
  v_fma_f32 v42, v42, s60, -v70
  v_fma_f32 v43, v43, s60, -v70
  v_fma_f32 v44, v44, s60, -v70
  v_fma_f32 v45, v45, s60, -v70
  v_fma_f32 v46, v46, s60, -v70
  v_fma_f32 v47, v47, s60, -v70
  v_exp_f32 v32, v32
  v_exp_f32 v33, v33
  v_exp_f32 v34, v34
  v_exp_f32 v35, v35
  v_exp_f32 v36, v36
  v_exp_f32 v37, v37
  v_exp_f32 v38, v38
  v_exp_f32 v39, v39
  v_exp_f32 v40, v40
  v_exp_f32 v41, v41
  v_exp_f32 v42, v42
  v_exp_f32 v43, v43
  v_exp_f32 v44, v44
  v_exp_f32 v45, v45
  v_exp_f32 v46, v46
  v_exp_f32 v47, v47
  v_add_f32 v72, v32, v36
  v_add_f32 v73, v33, v37
  v_add_f32 v74, v34, v38
  v_add_f32 v75, v35, v39
  v_add_f32 v76, v40, v44
  v_add_f32 v77, v41, v45
  v_add_f32 v78, v42, v46
  v_add_f32 v79, v43, v47
  v_add_f32 v72, v72, v76
  v_add_f32 v73, v73, v77
  v_add_f32 v74, v74, v78
  v_add_f32 v75, v75, v79
  v_add_f32 v72, v72, v73
  v_add_f32 v74, v74, v75
  v_add_f32 v71, v72, v74
  v_mov_b32 v69, v71
  s_nop 1
  v_permlane32_swap_b32 v69, v71
  v_add_f32 v71, v69, v71
  v_mov_b32 v69, v71
  s_nop 1
  v_permlane16_swap_b32 v69, v71
  v_add_f32 v71, v69, v71
  v_rcp_f32 v71, v71
  s_nop 0
  v_mul_f32 v32, v32, v71
  v_mul_f32 v33, v33, v71
  v_mul_f32 v34, v34, v71
  v_mul_f32 v35, v35, v71
  v_mul_f32 v36, v36, v71
  v_mul_f32 v37, v37, v71
  v_mul_f32 v38, v38, v71
  v_mul_f32 v39, v39, v71
  v_mul_f32 v40, v40, v71
  v_mul_f32 v41, v41, v71
  v_mul_f32 v42, v42, v71
  v_mul_f32 v43, v43, v71
  v_mul_f32 v44, v44, v71
  v_mul_f32 v45, v45, v71
  v_mul_f32 v46, v46, v71
  v_mul_f32 v47, v47, v71
  v_cvt_pk_bf16_f32 v48, v32, v33
  v_cvt_pk_bf16_f32 v49, v34, v35
  v_cvt_pk_bf16_f32 v50, v36, v37
  v_cvt_pk_bf16_f32 v51, v38, v39
  v_cvt_pk_bf16_f32 v52, v40, v41
  v_cvt_pk_bf16_f32 v53, v42, v43
  v_cvt_pk_bf16_f32 v54, v44, v45
  v_cvt_pk_bf16_f32 v55, v46, v47
  ds_write_b128 v26, v[48:51]
  ds_write_b128 v26, v[52:55] offset:1024
  s_waitcnt lgkmcnt(0)
L_sm1:
  s_barrier
  ds_read_b128 v[48:51], v26
  ds_read_b128 v[52:55], v26 offset:1024
  s_mov_b32 s100, 0x00030003
  s_mov_b32 s101, 0x00030003
  s_waitcnt lgkmcnt(0)
  v_mfma_f32_16x16x32_bf16 v[56:59], a[0:3], v[48:51], 0
  v_mfma_f32_16x16x32_bf16 v[60:63], a[8:11], v[48:51], 0
  v_mfma_f32_16x16x32_bf16 v[56:59], a[4:7], v[52:55], v[56:59]
  v_mfma_f32_16x16x32_bf16 v[60:63], a[12:15], v[52:55], v[60:63]
  s_nop 6
  v_cvt_pk_bf16_f32 v64, v56, v57
  v_cvt_pk_bf16_f32 v65, v58, v59
  v_cvt_pk_bf16_f32 v66, v60, v61
  v_cvt_pk_bf16_f32 v67, v62, v63
  s_mov_b64 exec, s[100:101]
  ds_write_b128 v24, v[64:67] offset:4096
  s_mov_b64 exec, -1
  v_mfma_f32_16x16x32_bf16 v[56:59], a[16:19], v[48:51], 0
  v_mfma_f32_16x16x32_bf16 v[60:63], a[24:27], v[48:51], 0
  v_mfma_f32_16x16x32_bf16 v[56:59], a[20:23], v[52:55], v[56:59]
  v_mfma_f32_16x16x32_bf16 v[60:63], a[28:31], v[52:55], v[60:63]
  s_nop 6
  v_cvt_pk_bf16_f32 v64, v56, v57
  v_cvt_pk_bf16_f32 v65, v58, v59
  v_cvt_pk_bf16_f32 v66, v60, v61
  v_cvt_pk_bf16_f32 v67, v62, v63
  s_mov_b64 exec, s[100:101]
  ds_write_b128 v24, v[64:67] offset:4224
  s_mov_b64 exec, -1
  v_mfma_f32_16x16x32_bf16 v[56:59], a[32:35], v[48:51], 0
  v_mfma_f32_16x16x32_bf16 v[60:63], a[40:43], v[48:51], 0
  v_mfma_f32_16x16x32_bf16 v[56:59], a[36:39], v[52:55], v[56:59]
  v_mfma_f32_16x16x32_bf16 v[60:63], a[44:47], v[52:55], v[60:63]
  s_nop 6
  v_cvt_pk_bf16_f32 v64, v56, v57
  v_cvt_pk_bf16_f32 v65, v58, v59
  v_cvt_pk_bf16_f32 v66, v60, v61
  v_cvt_pk_bf16_f32 v67, v62, v63
  s_mov_b64 exec, s[100:101]
  ds_write_b128 v24, v[64:67] offset:4352
  s_mov_b64 exec, -1
  v_mfma_f32_16x16x32_bf16 v[56:59], a[48:51], v[48:51], 0
  v_mfma_f32_16x16x32_bf16 v[60:63], a[56:59], v[48:51], 0
  v_mfma_f32_16x16x32_bf16 v[56:59], a[52:55], v[52:55], v[56:59]
  v_mfma_f32_16x16x32_bf16 v[60:63], a[60:63], v[52:55], v[60:63]
  s_nop 6
  v_cvt_pk_bf16_f32 v64, v56, v57
  v_cvt_pk_bf16_f32 v65, v58, v59
  v_cvt_pk_bf16_f32 v66, v60, v61
  v_cvt_pk_bf16_f32 v67, v62, v63
  s_mov_b64 exec, s[100:101]
  ds_write_b128 v24, v[64:67] offset:4480
  s_mov_b64 exec, -1
  v_mfma_f32_16x16x32_bf16 v[56:59], a[64:67], v[48:51], 0
  v_mfma_f32_16x16x32_bf16 v[60:63], a[72:75], v[48:51], 0
  v_mfma_f32_16x16x32_bf16 v[56:59], a[68:71], v[52:55], v[56:59]
  v_mfma_f32_16x16x32_bf16 v[60:63], a[76:79], v[52:55], v[60:63]
  s_nop 6
  v_cvt_pk_bf16_f32 v64, v56, v57
  v_cvt_pk_bf16_f32 v65, v58, v59
  v_cvt_pk_bf16_f32 v66, v60, v61
  v_cvt_pk_bf16_f32 v67, v62, v63
  s_mov_b64 exec, s[100:101]
  ds_write_b128 v24, v[64:67] offset:4608
  s_mov_b64 exec, -1
  v_mfma_f32_16x16x32_bf16 v[56:59], a[80:83], v[48:51], 0
  v_mfma_f32_16x16x32_bf16 v[60:63], a[88:91], v[48:51], 0
  v_mfma_f32_16x16x32_bf16 v[56:59], a[84:87], v[52:55], v[56:59]
  v_mfma_f32_16x16x32_bf16 v[60:63], a[92:95], v[52:55], v[60:63]
  s_nop 6
  v_cvt_pk_bf16_f32 v64, v56, v57
  v_cvt_pk_bf16_f32 v65, v58, v59
  v_cvt_pk_bf16_f32 v66, v60, v61
  v_cvt_pk_bf16_f32 v67, v62, v63
  s_mov_b64 exec, s[100:101]
  ds_write_b128 v24, v[64:67] offset:4736
  s_mov_b64 exec, -1
  v_mfma_f32_16x16x32_bf16 v[56:59], a[96:99], v[48:51], 0
  v_mfma_f32_16x16x32_bf16 v[60:63], a[104:107], v[48:51], 0
  v_mfma_f32_16x16x32_bf16 v[56:59], a[100:103], v[52:55], v[56:59]
  v_mfma_f32_16x16x32_bf16 v[60:63], a[108:111], v[52:55], v[60:63]
  s_nop 6
  v_cvt_pk_bf16_f32 v64, v56, v57
  v_cvt_pk_bf16_f32 v65, v58, v59
  v_cvt_pk_bf16_f32 v66, v60, v61
  v_cvt_pk_bf16_f32 v67, v62, v63
  s_mov_b64 exec, s[100:101]
  ds_write_b128 v24, v[64:67] offset:4864
  s_mov_b64 exec, -1
  v_mfma_f32_16x16x32_bf16 v[56:59], a[112:115], v[48:51], 0
  v_mfma_f32_16x16x32_bf16 v[60:63], a[120:123], v[48:51], 0
  v_mfma_f32_16x16x32_bf16 v[56:59], a[116:119], v[52:55], v[56:59]
  v_mfma_f32_16x16x32_bf16 v[60:63], a[124:127], v[52:55], v[60:63]
  s_nop 6
  v_cvt_pk_bf16_f32 v64, v56, v57
  v_cvt_pk_bf16_f32 v65, v58, v59
  v_cvt_pk_bf16_f32 v66, v60, v61
  v_cvt_pk_bf16_f32 v67, v62, v63
  s_mov_b64 exec, s[100:101]
  ds_write_b128 v24, v[64:67] offset:4992
  s_mov_b64 exec, -1
  s_waitcnt lgkmcnt(0)
  s_barrier
  s_barrier
  ds_read_b128 v[32:35], v19 offset:0
  ds_read_b128 v[36:39], v19 offset:512
  ds_read_b128 v[40:43], v19 offset:1024
  ds_read_b128 v[44:47], v19 offset:1536
  s_mov_b32 exec_hi, 0
  s_waitcnt lgkmcnt(2)
  v_add_f32 v32, v32, v36
  v_add_f32 v33, v33, v37
  v_add_f32 v34, v34, v38
  v_add_f32 v35, v35, v39
  s_waitcnt lgkmcnt(0)
  v_add_f32 v40, v40, v44
  v_add_f32 v41, v41, v45
  v_add_f32 v42, v42, v46
  v_add_f32 v43, v43, v47
  v_add_f32 v32, v32, v40
  v_add_f32 v33, v33, v41
  v_add_f32 v34, v34, v42
  v_add_f32 v35, v35, v43
  v_bfi_b32 v32, s97, v112, v32
  v_bfi_b32 v33, s97, v113, v33
  v_bfi_b32 v34, s97, v114, v34
  v_bfi_b32 v35, s97, v115, v35
  buffer_store_dwordx4 v[32:35], v20, s[48:51], s64 offen sc1
  s_mov_b64 exec, -1
  s_cmp_eq_u32 s3, 0
  s_cbranch_scc0 L_done
  s_mov_b32 s67, 1048576
L_poll:
  buffer_load_dwordx4 v[80:83], v21, s[48:51], s65 offen sc1
  buffer_load_dwordx4 v[84:87], v21, s[48:51], s65 offen offset:1024 sc1
  s_waitcnt vmcnt(0)
  v_perm_b32 v68, v81, v80, s95
  v_perm_b32 v69, v83, v82, s96
  v_perm_b32 v70, v85, v84, s95
  v_perm_b32 v71, v87, v86, s96
  v_or_b32 v68, v68, v69
  v_or_b32 v70, v70, v71
  v_xor_b32 v68, s94, v68
  v_xor_b32 v70, s94, v70
  v_or_b32 v68, v68, v70
  v_cmp_ne_u32 vcc, 0, v68
  s_sub_u32 s67, s67, 1
  s_cbranch_scc1 L_got
  s_cbranch_vccnz L_poll
L_got:
  v_and_b32 v80, 0xffffff00, v80
  v_and_b32 v81, 0xffffff00, v81
  v_and_b32 v82, 0xffffff00, v82
  v_and_b32 v83, 0xffffff00, v83
  v_and_b32 v84, 0xffffff00, v84
  v_and_b32 v85, 0xffffff00, v85
  v_and_b32 v86, 0xffffff00, v86
  v_and_b32 v87, 0xffffff00, v87
  v_add_f32 v80, v80, v84
  v_add_f32 v81, v81, v85
  v_add_f32 v82, v82, v86
  v_add_f32 v83, v83, v87
  v_permlane32_swap_b32 v80, v81
  s_nop 0
  v_permlane32_swap_b32 v82, v83
  v_add_f32 v80, v80, v81
  v_add_f32 v82, v82, v83
  s_nop 1
  v_permlane16_swap_b32 v80, v82
  v_add_f32 v80, v80, v82
  v_cvt_pk_bf16_f32 v84, v80, v80
  buffer_store_short v84, v22, s[40:43], s66 offen
L_done:
  s_endpgm
.section .rodata,"a"
.p2align 6
.amdhsa_kernel standalone__low_rank_proj_linformer__decode_kernel
  .amdhsa_next_free_vgpr 256
  .amdhsa_next_free_sgpr 102
  .amdhsa_accum_offset 128
  .amdhsa_group_segment_fixed_size 0
  .amdhsa_float_denorm_mode_32 3
  .amdhsa_kernarg_size 64
  .amdhsa_user_sgpr_count 2
  .amdhsa_user_sgpr_kernarg_segment_ptr 1
  .amdhsa_system_sgpr_workgroup_id_x 1
.end_amdhsa_kernel
```
